```python
import torch

def _softmax(x, axis=-1):
    return torch.softmax(x, dim=axis)
def _gelu(x):
    return torch.nn.functional.gelu(x, approximate="tanh")
def _silu(x):
    return torch.nn.functional.silu(x)
def _sigmoid(x):
    return torch.sigmoid(x)
def _layernorm(x, axis=-1, eps=1e-5):
    m = x.mean(dim=axis, keepdim=True)
    v = x.var(dim=axis, keepdim=True, unbiased=False)
    return (x - m) / torch.sqrt(v + eps)
def _scatter_add(tgt, idx, src, axis=0):
    return tgt.clone().index_add_(axis, idx, src)
def _segment_sum(src, seg, n):
    out = torch.zeros((n,) + src.shape[1:], dtype=src.dtype)
    return out.index_add_(0, seg, src)
def _pad(x, pw):
    flat = tuple(v for pair in reversed(pw) for v in pair)
    return torch.nn.functional.pad(x, flat)

kernel_name = 'recurrent_scan__gqa_block_cached__mixer_channel_mlp__decode'

def setup_inputs():

    _w = (lambda a: (lambda t: t.to(torch.bfloat16) if t.is_floating_point() else t)(torch.as_tensor(a)))
    def _A_setup():
        B, Sq, D = 1, 1, 512
        Hq, Hkv, Sk, Dh = 32, 8, 32768, 128
        assert Hq % Hkv == 0, (Hq, Hkv)
        return {
            "x": _w((lambda *s: torch.randn(*s, dtype=torch.bfloat16) * 0.1)(B, Sq, D)),
            "k_cache": _w((lambda *s: torch.randn(*s, dtype=torch.bfloat16) * 0.8)(B, Hkv, Sk, Dh)),
            "v_cache": _w((lambda *s: torch.randn(*s, dtype=torch.bfloat16) * 3.2)(B, Hkv, Sk, Dh)),
            "wq": _w((lambda *s: torch.randn(*s, dtype=torch.bfloat16) * 0.8)(D, Hq * Dh) * (D ** -0.5)),
            "wo": _w((lambda *s: torch.randn(*s, dtype=torch.bfloat16) * 3.2)(Hq * Dh, D) * ((Hq * Dh) ** -0.5)),
        }
    _A_in = _A_setup()

    def _B_setup():
        B, S, D, F = 1, 1, 512, 1792
        return {
            "x": _w((lambda *s: torch.randn(*s, dtype=torch.bfloat16) * 0.1)(B, S, D)),
            "w1": _w((lambda *s: torch.randn(*s, dtype=torch.bfloat16) * 3.2)(D, F) * (D ** -0.5)),
            "b1": _w((lambda *s: torch.randn(*s, dtype=torch.bfloat16) * 3.2)(F)),
            "w2": _w((lambda *s: torch.randn(*s, dtype=torch.bfloat16) * 3.2)(F, D) * (F ** -0.5)),
            "b2": _w((lambda *s: torch.randn(*s, dtype=torch.bfloat16) * 3.2)(D)),
        }
    _B_in = _B_setup()

    return {
        "A_x": _A_in["x"],
        "A_k_cache": _A_in["k_cache"],
        "A_v_cache": _A_in["v_cache"],
        "A_wq": _A_in["wq"],
        "A_wo": _A_in["wo"],
        "B_x": _B_in["x"],
        "B_w1": _B_in["w1"],
        "B_b1": _B_in["b1"],
        "B_w2": _B_in["w2"],
        "B_b2": _B_in["b2"],
    }

def reference(A_x, A_k_cache, A_v_cache, A_wq, A_wo, B_x, B_w1, B_b1, B_w2, B_b2):
    def _A_ref(x, k_cache, v_cache, wq, wo):
        B, Sq, D = x.shape
        Hq, Dh = 32, 128
        Hkv = k_cache.shape[1]
        rep = Hq // Hkv
        q = (lambda x, *d: x.permute(*d))((x @ wq).reshape(B, Sq, Hq, Dh), 0, 2, 1, 3)
        k = (lambda x, n, axis: torch.repeat_interleave(x, n, dim=axis))(k_cache, rep, axis=1)
        v = (lambda x, n, axis: torch.repeat_interleave(x, n, dim=axis))(v_cache, rep, axis=1)
        scores = torch.einsum("bhqd,bhkd->bhqk", q, k) * (Dh ** -0.5)
        p = _softmax(scores, axis=-1)
        o = torch.einsum("bhqk,bhkd->bhqd", p, v)
        return (lambda x, *d: x.permute(*d))(o, 0, 2, 1, 3).reshape(B, Sq, Hq * Dh) @ wo

    def _B_ref(x, w1, b1, w2, b2):
        y = _layernorm(x, axis=-1)
        h = _gelu(torch.einsum("bsd,df->bsf", y, w1) + b1)
        return torch.einsum("bsf,fd->bsd", h, w2) + b2

    x = A_x
    xn = _layernorm(x, axis=-1)
    s = _A_ref(xn, A_k_cache, A_v_cache, A_wq, A_wo)
    g = _silu(_B_ref(xn, B_w1, B_b1, B_w2, B_b2))
    return x + s * g
```

```asm
; @launch kernel=k1_kernel grid=(184,1,1) block=(256,1,1) lds=12288
; @launch kernel=k2_kernel grid=(256,1,1) block=(512,1,1) lds=147968
; @launch kernel=k3_kernel grid=(80,1,1) block=(256,1,1) lds=12288
.amdgcn_target "amdgcn-amd-amdhsa--gfx950"
.text

.macro WSUM v, t
  s_nop 1
  v_add_f32_dpp \v, \v, \v quad_perm:[1,0,3,2] row_mask:0xf bank_mask:0xf
  s_nop 1
  v_add_f32_dpp \v, \v, \v quad_perm:[2,3,0,1] row_mask:0xf bank_mask:0xf
  s_nop 1
  v_add_f32_dpp \v, \v, \v row_half_mirror row_mask:0xf bank_mask:0xf
  s_nop 1
  v_add_f32_dpp \v, \v, \v row_mirror row_mask:0xf bank_mask:0xf
  v_mov_b32 \t, \v
  s_nop 1
  v_permlane16_swap_b32 \v, \t
  v_add_f32 \v, \v, \t
  v_mov_b32 \t, \v
  s_nop 1
  v_permlane32_swap_b32 \v, \t
  v_add_f32 \v, \v, \t
.endm
.macro RBF v
  v_cvt_pk_bf16_f32 \v, \v, \v
  v_lshlrev_b32 \v, 16, \v
.endm
.macro BSUM v, t, q, vw, lo
  WSUM \v, \t
  s_barrier
  ds_write_b32 \vw, \v offset:\lo
  s_waitcnt lgkmcnt(0)
  s_barrier
  v_mov_b32 \t, 0
  ds_read_b128 v[\q:\q+3], \t offset:\lo
  s_waitcnt lgkmcnt(0)
  v_add_f32 \v, v[\q], v[\q+1]
  v_add_f32 \t, v[\q+2], v[\q+3]
  v_add_f32 \v, \v, \t
.endm
.macro LNORM a, b
  v_add_f32 v20, \a, \b
  BSUM v20, v21, 24, v19, 8192
  v_mul_f32 v20, 0x3b000000, v20
  v_sub_f32 v22, \a, v20
  v_sub_f32 v23, \b, v20
  v_mul_f32 v22, v22, v22
  v_fmac_f32 v22, v23, v23
  BSUM v22, v21, 24, v19, 8192
  v_mul_f32 v22, 0x3b000000, v22
  RBF v22
  RBF v20
  v_add_f32 v22, 0x3727c5ac, v22
  RBF v22
  v_sqrt_f32 v22, v22
  s_nop 0
  RBF v22
  v_rcp_f32 v22, v22
  v_sub_f32 \a, \a, v20
  v_sub_f32 \b, \b, v20
  RBF \a
  RBF \b
  v_mul_f32 \a, \a, v22
  v_mul_f32 \b, \b, v22
  RBF \a
  RBF \b
.endm
.macro FMA8 a, d, x
  v_lshlrev_b32 v28, 16, v[\d]
  v_and_b32 v29, 0xffff0000, v[\d]
  v_fmac_f32 v[\a], v28, \x
  v_fmac_f32 v[\a+1], v29, \x
  v_lshlrev_b32 v28, 16, v[\d+1]
  v_and_b32 v29, 0xffff0000, v[\d+1]
  v_fmac_f32 v[\a+2], v28, \x
  v_fmac_f32 v[\a+3], v29, \x
  v_lshlrev_b32 v28, 16, v[\d+2]
  v_and_b32 v29, 0xffff0000, v[\d+2]
  v_fmac_f32 v[\a+4], v28, \x
  v_fmac_f32 v[\a+5], v29, \x
  v_lshlrev_b32 v28, 16, v[\d+3]
  v_and_b32 v29, 0xffff0000, v[\d+3]
  v_fmac_f32 v[\a+6], v28, \x
  v_fmac_f32 v[\a+7], v29, \x
.endm

.globl k1_kernel
.p2align 8
.type k1_kernel,@function
k1_kernel:

  s_cmp_ge_u32 s2, 184
  s_cbranch_scc1 k1_end
  s_load_dwordx2 s[4:5], s[0:1], 0
  s_load_dwordx2 s[6:7], s[0:1], 24
  s_load_dwordx2 s[8:9], s[0:1], 48
  s_load_dwordx2 s[10:11], s[0:1], 56
  s_load_dwordx2 s[12:13], s[0:1], 96
  v_lshlrev_b32 v1, 2, v0
  v_lshrrev_b32 v19, 6, v0
  v_lshlrev_b32 v19, 2, v19
  s_waitcnt lgkmcnt(0)
  global_load_dword v2, v1, s[4:5]
  s_cmp_ge_u32 s2, 128
  s_cselect_b32 s16, s8, s6
  s_cselect_b32 s17, s9, s7
  s_mov_b32 s18, 0x2000
  s_mov_b32 s19, 0x400000
  s_cselect_b32 s18, 0xe00, s18
  s_cselect_b32 s19, 0x1c0000, s19
  s_cselect_b32 s20, 128, 0
  s_sub_u32 s20, s2, s20
  s_lshl_b32 s20, s20, 6
  s_mov_b32 s24, s16
  s_mov_b32 s25, s17
  s_mov_b32 s26, s19
  s_mov_b32 s27, 0x00020000
  v_lshrrev_b32 v4, 2, v0
  v_mul_lo_u32 v5, v4, s18
  v_and_b32 v6, 3, v0
  v_lshl_add_u32 v5, v6, 4, v5
  v_add_u32 v5, s20, v5
  s_lshl_b32 s21, s18, 6
  s_mov_b32 s22, 0

  buffer_load_dwordx4 v[32:35], v5, s[24:27], s22 offen
  s_add_u32 s22, s22, s21
  buffer_load_dwordx4 v[36:39], v5, s[24:27], s22 offen
  s_add_u32 s22, s22, s21
  buffer_load_dwordx4 v[40:43], v5, s[24:27], s22 offen
  s_add_u32 s22, s22, s21
  buffer_load_dwordx4 v[44:47], v5, s[24:27], s22 offen
  s_add_u32 s22, s22, s21
  buffer_load_dwordx4 v[48:51], v5, s[24:27], s22 offen
  s_add_u32 s22, s22, s21
  buffer_load_dwordx4 v[52:55], v5, s[24:27], s22 offen
  s_add_u32 s22, s22, s21
  buffer_load_dwordx4 v[56:59], v5, s[24:27], s22 offen
  s_add_u32 s22, s22, s21
  buffer_load_dwordx4 v[60:63], v5, s[24:27], s22 offen
  s_add_u32 s22, s22, s21

  s_waitcnt vmcnt(8)
  v_and_b32 v3, 0xffff0000, v2
  v_lshlrev_b32 v2, 16, v2
  LNORM v2, v3
  s_cmp_ge_u32 s2, 128
  s_cbranch_scc0 k1_noln2
  LNORM v2, v3
k1_noln2:
  v_lshlrev_b32 v1, 3, v0
  ds_write_b64 v1, v[2:3] offset:9728
  s_waitcnt lgkmcnt(0)
  s_barrier
  v_lshlrev_b32 v4, 2, v4

  ds_read_b32 v64, v4 offset:9728
  ds_read_b32 v65, v4 offset:9984
  ds_read_b32 v66, v4 offset:10240
  ds_read_b32 v67, v4 offset:10496
  ds_read_b32 v68, v4 offset:10752
  ds_read_b32 v69, v4 offset:11008
  ds_read_b32 v70, v4 offset:11264
  ds_read_b32 v71, v4 offset:11520
  v_mov_b32 v8, 0
  v_mov_b32 v9, 0
  v_mov_b32 v10, 0
  v_mov_b32 v11, 0
  v_mov_b32 v12, 0
  v_mov_b32 v13, 0
  v_mov_b32 v14, 0
  v_mov_b32 v15, 0
  s_waitcnt vmcnt(0) lgkmcnt(0)
  FMA8 8, 32, v64
  FMA8 8, 36, v65
  FMA8 8, 40, v66
  FMA8 8, 44, v67
  FMA8 8, 48, v68
  FMA8 8, 52, v69
  FMA8 8, 56, v70
  FMA8 8, 60, v71

  s_barrier
  v_lshlrev_b32 v16, 5, v0
  ds_write_b128 v16, v[8:11]
  ds_write_b128 v16, v[12:15] offset:16
  s_waitcnt lgkmcnt(0)
  s_barrier
  v_and_b32 v16, 31, v0
  v_lshrrev_b32 v17, 5, v0
  v_lshlrev_b32 v17, 10, v17
  v_lshl_add_u32 v16, v16, 2, v17
  ds_read_b32 v8, v16
  ds_read_b32 v9, v16 offset:128
  ds_read_b32 v10, v16 offset:256
  ds_read_b32 v11, v16 offset:384
  ds_read_b32 v12, v16 offset:512
  ds_read_b32 v13, v16 offset:640
  ds_read_b32 v14, v16 offset:768
  ds_read_b32 v15, v16 offset:896
  s_waitcnt lgkmcnt(0)
  v_add_f32 v8, v8, v9
  v_add_f32 v10, v10, v11
  v_add_f32 v12, v12, v13
  v_add_f32 v14, v14, v15
  v_add_f32 v8, v8, v10
  v_add_f32 v12, v12, v14
  v_add_f32 v8, v8, v12
  v_lshlrev_b32 v16, 2, v0
  ds_write_b32 v16, v8 offset:8448
  s_waitcnt lgkmcnt(0)
  s_barrier
  v_and_b32 v16, 31, v0
  v_lshlrev_b32 v16, 2, v16
  ds_read_b32 v8, v16 offset:8448
  ds_read_b32 v9, v16 offset:8576
  ds_read_b32 v10, v16 offset:8704
  ds_read_b32 v11, v16 offset:8832
  ds_read_b32 v12, v16 offset:8960
  ds_read_b32 v13, v16 offset:9088
  ds_read_b32 v14, v16 offset:9216
  ds_read_b32 v15, v16 offset:9344
  s_waitcnt lgkmcnt(0)
  v_add_f32 v8, v8, v9
  v_add_f32 v10, v10, v11
  v_add_f32 v12, v12, v13
  v_add_f32 v14, v14, v15
  v_add_f32 v8, v8, v10
  v_add_f32 v12, v12, v14
  v_add_f32 v8, v8, v12

  v_cmp_gt_u32 vcc, 32, v0
  s_and_saveexec_b64 s[30:31], vcc
  s_cbranch_execz k1_end
  s_cmp_ge_u32 s2, 128
  s_cbranch_scc1 k1_h
  v_cvt_pk_bf16_f32 v8, v8, v8
  s_lshl_b32 s3, s2, 6
  v_lshl_add_u32 v9, v0, 1, s3
  global_store_short v9, v8, s[12:13]
  s_branch k1_end
k1_h:
  s_sub_u32 s3, s2, 128
  s_lshl_b32 s3, s3, 6
  v_lshl_add_u32 v9, v0, 1, s3
  global_load_ushort v10, v9, s[10:11]
  RBF v8
  s_waitcnt vmcnt(0)
  v_lshlrev_b32 v10, 16, v10
  v_add_f32 v8, v8, v10
  RBF v8
  v_mul_f32 v10, v8, v8
  v_mul_f32 v10, v10, v8
  v_mov_b32 v11, 0x3d372713
  v_fma_f32 v10, v10, v11, v8
  v_mul_f32 v10, 0x40135761, v10
  v_exp_f32 v10, v10
  s_nop 0
  v_add_f32 v10, 1.0, v10
  v_rcp_f32 v10, v10
  s_nop 0
  v_fma_f32 v10, v10, -2.0, 2.0
  v_mul_f32 v10, 0.5, v10
  v_mul_f32 v8, v8, v10
  RBF v8
  v_lshlrev_b32 v9, 1, v9
  v_add_u32 v9, 8192, v9
  global_store_dword v9, v8, s[12:13]
k1_end:
  s_endpgm

.section .rodata,"a"
.p2align 6
.amdhsa_kernel k1_kernel
  .amdhsa_next_free_vgpr 72
  .amdhsa_next_free_sgpr 64
  .amdhsa_accum_offset 72
  .amdhsa_group_segment_fixed_size 0
  .amdhsa_kernarg_size 104
  .amdhsa_user_sgpr_count 2
  .amdhsa_user_sgpr_kernarg_segment_ptr 1
  .amdhsa_system_sgpr_workgroup_id_x 1
.end_amdhsa_kernel
.text
.globl k2_kernel
.p2align 8
.type k2_kernel,@function
k2_kernel:

  s_cmp_ge_u32 s2, 256
  s_cbranch_scc1 k2_end
  s_load_dwordx2 s[4:5], s[0:1], 8
  s_load_dwordx2 s[6:7], s[0:1], 16
  s_load_dwordx2 s[12:13], s[0:1], 96
  v_lshrrev_b32 v5, 6, v0
  v_and_b32 v1, 63, v0
  s_nop 0
  v_readfirstlane_b32 s3, v5
  s_and_b32 s14, s2, 7
  s_lshr_b32 s15, s2, 3
  s_lshl_b32 s16, s14, 23
  s_lshl_b32 s17, s15, 18
  s_add_u32 s16, s16, s17
  s_lshl_b32 s17, s3, 13
  s_add_u32 s16, s16, s17
  s_waitcnt lgkmcnt(0)
  s_add_u32 s20, s4, s16
  s_addc_u32 s21, s5, 0
  s_mov_b32 s22, 0x38000
  s_mov_b32 s23, 0x00020000
  s_add_u32 s24, s6, s16
  s_addc_u32 s25, s7, 0
  s_mov_b32 s26, 0x38000
  s_mov_b32 s27, 0x00020000
  s_lshl_b32 s17, s14, 10
  s_add_u32 s28, s12, s17
  s_addc_u32 s29, s13, 0
  s_mov_b32 s30, 1024
  s_mov_b32 s31, 0x00020000
  v_and_b32 v5, 15, v1
  v_lshrrev_b32 v6, 4, v1
  v_lshlrev_b32 v2, 8, v5
  v_lshl_add_u32 v2, v6, 4, v2
  v_lshlrev_b32 v7, 1, v6
  v_xor_b32 v7, v5, v7
  v_lshlrev_b32 v7, 4, v7
  v_lshl_add_u32 v3, v6, 8, v7
  v_xor_b32 v4, 0x80, v3
  s_lshl_b32 s33, s3, 14
  v_lshrrev_b32 v7, 2, v5
  v_lshl_add_u32 v110, v6, 2, v7
  v_and_b32 v111, 7, v110
  v_lshlrev_b32 v111, 1, v111
  v_lshlrev_b32 v110, 8, v110
  v_add_u32 v110, s33, v110
  v_and_b32 v112, 1, v5
  v_lshl_add_u32 v110, v112, 3, v110
  v_bfe_u32 v112, v5, 1, 1

  v_or_b32 v113, 0, v112
  v_xor_b32 v113, v113, v111
  v_lshl_add_u32 v8, v113, 4, v110
  v_or_b32 v113, 2, v112
  v_xor_b32 v113, v113, v111
  v_lshl_add_u32 v9, v113, 4, v110
  v_or_b32 v113, 4, v112
  v_xor_b32 v113, v113, v111
  v_lshl_add_u32 v10, v113, 4, v110
  v_or_b32 v113, 6, v112
  v_xor_b32 v113, v113, v111
  v_lshl_add_u32 v11, v113, 4, v110
  v_or_b32 v113, 8, v112
  v_xor_b32 v113, v113, v111
  v_lshl_add_u32 v12, v113, 4, v110
  v_or_b32 v113, 10, v112
  v_xor_b32 v113, v113, v111
  v_lshl_add_u32 v13, v113, 4, v110
  v_or_b32 v113, 12, v112
  v_xor_b32 v113, v113, v111
  v_lshl_add_u32 v14, v113, 4, v110
  v_or_b32 v113, 14, v112
  v_xor_b32 v113, v113, v111
  v_lshl_add_u32 v15, v113, 4, v110
  buffer_load_dwordx4 v[16:19], v2, s[28:31], 0 offen offset:0 nt
  buffer_load_dwordx4 v[20:23], v2, s[28:31], 0 offen offset:64 nt
  buffer_load_dwordx4 v[24:27], v2, s[28:31], 0 offen offset:128 nt
  buffer_load_dwordx4 v[28:31], v2, s[28:31], 0 offen offset:192 nt
  s_mov_b32 s40, 0
  s_mov_b32 s41, 4096
  s_mov_b32 s42, 65536
  s_mov_b32 s43, 69632
  s_mov_b32 s44, 131072
  s_mov_b32 s45, 135168
  s_mov_b32 s46, 196608
  s_mov_b32 s47, 200704
  buffer_load_dwordx4 v[32:35], v2, s[20:23], s40 offen offset:0 nt
  buffer_load_dwordx4 v[36:39], v2, s[20:23], s40 offen offset:64 nt
  buffer_load_dwordx4 v[40:43], v2, s[20:23], s40 offen offset:128 nt
  buffer_load_dwordx4 v[44:47], v2, s[20:23], s40 offen offset:192 nt
  buffer_load_dwordx4 v[48:51], v2, s[20:23], s41 offen offset:0 nt
  buffer_load_dwordx4 v[52:55], v2, s[20:23], s41 offen offset:64 nt
  buffer_load_dwordx4 v[56:59], v2, s[20:23], s41 offen offset:128 nt
  buffer_load_dwordx4 v[60:63], v2, s[20:23], s41 offen offset:192 nt
  s_add_u32 s34, s33, 0
  s_mov_b32 m0, s34
  s_nop 0
  buffer_load_dwordx4 v3, s[24:27], s40 offen offset:0 nt lds
  buffer_load_dwordx4 v4, s[24:27], s40 offen offset:1024 nt lds
  buffer_load_dwordx4 v3, s[24:27], s40 offen offset:2048 nt lds
  buffer_load_dwordx4 v4, s[24:27], s40 offen offset:3072 nt lds
  s_add_u32 s34, s33, 4096
  s_mov_b32 m0, s34
  s_nop 0
  buffer_load_dwordx4 v3, s[24:27], s41 offen offset:0 nt lds
  buffer_load_dwordx4 v4, s[24:27], s41 offen offset:1024 nt lds
  buffer_load_dwordx4 v3, s[24:27], s41 offen offset:2048 nt lds
  buffer_load_dwordx4 v4, s[24:27], s41 offen offset:3072 nt lds
  buffer_load_dwordx4 v[64:67], v2, s[20:23], s42 offen offset:0 nt
  buffer_load_dwordx4 v[68:71], v2, s[20:23], s42 offen offset:64 nt
  buffer_load_dwordx4 v[72:75], v2, s[20:23], s42 offen offset:128 nt
  buffer_load_dwordx4 v[76:79], v2, s[20:23], s42 offen offset:192 nt
  buffer_load_dwordx4 v[80:83], v2, s[20:23], s43 offen offset:0 nt
  buffer_load_dwordx4 v[84:87], v2, s[20:23], s43 offen offset:64 nt
  buffer_load_dwordx4 v[88:91], v2, s[20:23], s43 offen offset:128 nt
  buffer_load_dwordx4 v[92:95], v2, s[20:23], s43 offen offset:192 nt
  s_add_u32 s34, s33, 8192
  s_mov_b32 m0, s34
  s_nop 0
  buffer_load_dwordx4 v3, s[24:27], s42 offen offset:0 nt lds
  buffer_load_dwordx4 v4, s[24:27], s42 offen offset:1024 nt lds
  buffer_load_dwordx4 v3, s[24:27], s42 offen offset:2048 nt lds
  buffer_load_dwordx4 v4, s[24:27], s42 offen offset:3072 nt lds
  s_add_u32 s34, s33, 12288
  s_mov_b32 m0, s34
  s_nop 0
  buffer_load_dwordx4 v3, s[24:27], s43 offen offset:0 nt lds
  buffer_load_dwordx4 v4, s[24:27], s43 offen offset:1024 nt lds
  buffer_load_dwordx4 v3, s[24:27], s43 offen offset:2048 nt lds
  buffer_load_dwordx4 v4, s[24:27], s43 offen offset:3072 nt lds
  v_mov_b32 v160, 0
  v_mov_b32 v161, 0
  v_mov_b32 v162, 0
  v_mov_b32 v163, 0
  v_mov_b32 v164, 0
  v_mov_b32 v165, 0
  v_mov_b32 v166, 0
  v_mov_b32 v167, 0
  v_mov_b32 v168, 0
  v_mov_b32 v169, 0
  v_mov_b32 v170, 0
  v_mov_b32 v171, 0
  v_mov_b32 v172, 0
  v_mov_b32 v173, 0
  v_mov_b32 v174, 0
  v_mov_b32 v175, 0
  v_mov_b32 v176, 0
  v_mov_b32 v177, 0
  v_mov_b32 v178, 0
  v_mov_b32 v179, 0
  v_mov_b32 v180, 0
  v_mov_b32 v181, 0
  v_mov_b32 v182, 0
  v_mov_b32 v183, 0
  v_mov_b32 v184, 0
  v_mov_b32 v185, 0
  v_mov_b32 v186, 0
  v_mov_b32 v187, 0
  v_mov_b32 v188, 0
  v_mov_b32 v189, 0
  v_mov_b32 v190, 0
  v_mov_b32 v191, 0
  v_mov_b32 v108, 0xff800000
  v_mov_b32 v109, 0
  s_mov_b32 s35, 0x3e0293ee
  s_waitcnt vmcnt(16)
  v_mov_b32 v96, 0
  v_mov_b32 v97, 0
  v_mov_b32 v98, 0
  v_mov_b32 v99, 0
  v_mov_b32 v100, 0
  v_mov_b32 v101, 0
  v_mov_b32 v102, 0
  v_mov_b32 v103, 0
  s_nop 1
  v_mfma_f32_16x16x32_bf16 v[96:99], v[32:35], v[16:19], v[96:99]
  v_mfma_f32_16x16x32_bf16 v[96:99], v[36:39], v[20:23], v[96:99]
  v_mfma_f32_16x16x32_bf16 v[96:99], v[40:43], v[24:27], v[96:99]
  v_mfma_f32_16x16x32_bf16 v[96:99], v[44:47], v[28:31], v[96:99]
  v_mfma_f32_16x16x32_bf16 v[100:103], v[48:51], v[16:19], v[100:103]
  v_mfma_f32_16x16x32_bf16 v[100:103], v[52:55], v[20:23], v[100:103]
  v_mfma_f32_16x16x32_bf16 v[100:103], v[56:59], v[24:27], v[100:103]
  v_mfma_f32_16x16x32_bf16 v[100:103], v[60:63], v[28:31], v[100:103]
  ds_read_b64_tr_b16 v[128:129], v8 offset:0
  ds_read_b64_tr_b16 v[130:131], v8 offset:4096
  ds_read_b64_tr_b16 v[132:133], v9 offset:0
  ds_read_b64_tr_b16 v[134:135], v9 offset:4096
  ds_read_b64_tr_b16 v[136:137], v10 offset:0
  ds_read_b64_tr_b16 v[138:139], v10 offset:4096
  ds_read_b64_tr_b16 v[140:141], v11 offset:0
  ds_read_b64_tr_b16 v[142:143], v11 offset:4096
  ds_read_b64_tr_b16 v[144:145], v12 offset:0
  ds_read_b64_tr_b16 v[146:147], v12 offset:4096
  ds_read_b64_tr_b16 v[148:149], v13 offset:0
  ds_read_b64_tr_b16 v[150:151], v13 offset:4096
  ds_read_b64_tr_b16 v[152:153], v14 offset:0
  ds_read_b64_tr_b16 v[154:155], v14 offset:4096
  ds_read_b64_tr_b16 v[156:157], v15 offset:0
  ds_read_b64_tr_b16 v[158:159], v15 offset:4096
  s_nop 7
  v_max3_f32 v110, v96, v97, v98
  v_max3_f32 v111, v99, v100, v101
  v_max3_f32 v110, v110, v102, v103
  v_max_f32 v110, v110, v111
  v_mov_b32 v111, v110
  s_nop 1
  v_permlane16_swap_b32 v110, v111
  v_max_f32 v110, v110, v111
  v_mov_b32 v111, v110
  s_nop 1
  v_permlane32_swap_b32 v110, v111
  v_max3_f32 v110, v110, v111, v108
  v_sub_f32 v111, v108, v110
  v_mul_f32 v111, s35, v111
  v_exp_f32 v111, v111
  v_mov_b32 v108, v110
  v_mul_f32 v112, s35, v110
  v_fma_f32 v96, v96, s35, -v112
  v_exp_f32 v96, v96
  v_fma_f32 v97, v97, s35, -v112
  v_exp_f32 v97, v97
  v_fma_f32 v98, v98, s35, -v112
  v_exp_f32 v98, v98
  v_fma_f32 v99, v99, s35, -v112
  v_exp_f32 v99, v99
  v_fma_f32 v100, v100, s35, -v112
  v_exp_f32 v100, v100
  v_fma_f32 v101, v101, s35, -v112
  v_exp_f32 v101, v101
  v_fma_f32 v102, v102, s35, -v112
  v_exp_f32 v102, v102
  v_fma_f32 v103, v103, s35, -v112
  v_exp_f32 v103, v103
  s_nop 0
  v_mul_f32 v109, v109, v111
  v_add_f32 v109, v109, v96
  v_add_f32 v109, v109, v97
  v_add_f32 v109, v109, v98
  v_add_f32 v109, v109, v99
  v_add_f32 v109, v109, v100
  v_add_f32 v109, v109, v101
  v_add_f32 v109, v109, v102
  v_add_f32 v109, v109, v103
  v_cvt_pk_bf16_f32 v104, v96, v97
  v_cvt_pk_bf16_f32 v105, v98, v99
  v_cvt_pk_bf16_f32 v106, v100, v101
  v_cvt_pk_bf16_f32 v107, v102, v103
  v_readlane_b32 s50, v111, 0
  v_readlane_b32 s51, v111, 1
  v_readlane_b32 s52, v111, 2
  v_readlane_b32 s53, v111, 3
  s_nop 1
  v_mul_f32 v160, s50, v160
  v_mul_f32 v161, s51, v161
  v_mul_f32 v162, s52, v162
  v_mul_f32 v163, s53, v163
  v_mul_f32 v164, s50, v164
  v_mul_f32 v165, s51, v165
  v_mul_f32 v166, s52, v166
  v_mul_f32 v167, s53, v167
  v_mul_f32 v168, s50, v168
  v_mul_f32 v169, s51, v169
  v_mul_f32 v170, s52, v170
  v_mul_f32 v171, s53, v171
  v_mul_f32 v172, s50, v172
  v_mul_f32 v173, s51, v173
  v_mul_f32 v174, s52, v174
  v_mul_f32 v175, s53, v175
  v_mul_f32 v176, s50, v176
  v_mul_f32 v177, s51, v177
  v_mul_f32 v178, s52, v178
  v_mul_f32 v179, s53, v179
  v_mul_f32 v180, s50, v180
  v_mul_f32 v181, s51, v181
  v_mul_f32 v182, s52, v182
  v_mul_f32 v183, s53, v183
  v_mul_f32 v184, s50, v184
  v_mul_f32 v185, s51, v185
  v_mul_f32 v186, s52, v186
  v_mul_f32 v187, s53, v187
  v_mul_f32 v188, s50, v188
  v_mul_f32 v189, s51, v189
  v_mul_f32 v190, s52, v190
  v_mul_f32 v191, s53, v191
  s_waitcnt lgkmcnt(0)
  s_nop 1
  v_mfma_f32_16x16x32_bf16 v[160:163], v[104:107], v[128:131], v[160:163]
  v_mfma_f32_16x16x32_bf16 v[164:167], v[104:107], v[132:135], v[164:167]
  v_mfma_f32_16x16x32_bf16 v[168:171], v[104:107], v[136:139], v[168:171]
  v_mfma_f32_16x16x32_bf16 v[172:175], v[104:107], v[140:143], v[172:175]
  v_mfma_f32_16x16x32_bf16 v[176:179], v[104:107], v[144:147], v[176:179]
  v_mfma_f32_16x16x32_bf16 v[180:183], v[104:107], v[148:151], v[180:183]
  v_mfma_f32_16x16x32_bf16 v[184:187], v[104:107], v[152:155], v[184:187]
  v_mfma_f32_16x16x32_bf16 v[188:191], v[104:107], v[156:159], v[188:191]
  s_nop 7
  buffer_load_dwordx4 v[32:35], v2, s[20:23], s44 offen offset:0 nt
  buffer_load_dwordx4 v[36:39], v2, s[20:23], s44 offen offset:64 nt
  buffer_load_dwordx4 v[40:43], v2, s[20:23], s44 offen offset:128 nt
  buffer_load_dwordx4 v[44:47], v2, s[20:23], s44 offen offset:192 nt
  buffer_load_dwordx4 v[48:51], v2, s[20:23], s45 offen offset:0 nt
  buffer_load_dwordx4 v[52:55], v2, s[20:23], s45 offen offset:64 nt
  buffer_load_dwordx4 v[56:59], v2, s[20:23], s45 offen offset:128 nt
  buffer_load_dwordx4 v[60:63], v2, s[20:23], s45 offen offset:192 nt
  s_add_u32 s34, s33, 0
  s_mov_b32 m0, s34
  s_nop 0
  buffer_load_dwordx4 v3, s[24:27], s44 offen offset:0 nt lds
  buffer_load_dwordx4 v4, s[24:27], s44 offen offset:1024 nt lds
  buffer_load_dwordx4 v3, s[24:27], s44 offen offset:2048 nt lds
  buffer_load_dwordx4 v4, s[24:27], s44 offen offset:3072 nt lds
  s_add_u32 s34, s33, 4096
  s_mov_b32 m0, s34
  s_nop 0
  buffer_load_dwordx4 v3, s[24:27], s45 offen offset:0 nt lds
  buffer_load_dwordx4 v4, s[24:27], s45 offen offset:1024 nt lds
  buffer_load_dwordx4 v3, s[24:27], s45 offen offset:2048 nt lds
  buffer_load_dwordx4 v4, s[24:27], s45 offen offset:3072 nt lds
  s_waitcnt vmcnt(16)
  v_mov_b32 v96, 0
  v_mov_b32 v97, 0
  v_mov_b32 v98, 0
  v_mov_b32 v99, 0
  v_mov_b32 v100, 0
  v_mov_b32 v101, 0
  v_mov_b32 v102, 0
  v_mov_b32 v103, 0
  s_nop 1
  v_mfma_f32_16x16x32_bf16 v[96:99], v[64:67], v[16:19], v[96:99]
  v_mfma_f32_16x16x32_bf16 v[96:99], v[68:71], v[20:23], v[96:99]
  v_mfma_f32_16x16x32_bf16 v[96:99], v[72:75], v[24:27], v[96:99]
  v_mfma_f32_16x16x32_bf16 v[96:99], v[76:79], v[28:31], v[96:99]
  v_mfma_f32_16x16x32_bf16 v[100:103], v[80:83], v[16:19], v[100:103]
  v_mfma_f32_16x16x32_bf16 v[100:103], v[84:87], v[20:23], v[100:103]
  v_mfma_f32_16x16x32_bf16 v[100:103], v[88:91], v[24:27], v[100:103]
  v_mfma_f32_16x16x32_bf16 v[100:103], v[92:95], v[28:31], v[100:103]
  ds_read_b64_tr_b16 v[128:129], v8 offset:8192
  ds_read_b64_tr_b16 v[130:131], v8 offset:12288
  ds_read_b64_tr_b16 v[132:133], v9 offset:8192
  ds_read_b64_tr_b16 v[134:135], v9 offset:12288
  ds_read_b64_tr_b16 v[136:137], v10 offset:8192
  ds_read_b64_tr_b16 v[138:139], v10 offset:12288
  ds_read_b64_tr_b16 v[140:141], v11 offset:8192
  ds_read_b64_tr_b16 v[142:143], v11 offset:12288
  ds_read_b64_tr_b16 v[144:145], v12 offset:8192
  ds_read_b64_tr_b16 v[146:147], v12 offset:12288
  ds_read_b64_tr_b16 v[148:149], v13 offset:8192
  ds_read_b64_tr_b16 v[150:151], v13 offset:12288
  ds_read_b64_tr_b16 v[152:153], v14 offset:8192
  ds_read_b64_tr_b16 v[154:155], v14 offset:12288
  ds_read_b64_tr_b16 v[156:157], v15 offset:8192
  ds_read_b64_tr_b16 v[158:159], v15 offset:12288
  s_nop 7
  v_max3_f32 v110, v96, v97, v98
  v_max3_f32 v111, v99, v100, v101
  v_max3_f32 v110, v110, v102, v103
  v_max_f32 v110, v110, v111
  v_mov_b32 v111, v110
  s_nop 1
  v_permlane16_swap_b32 v110, v111
  v_max_f32 v110, v110, v111
  v_mov_b32 v111, v110
  s_nop 1
  v_permlane32_swap_b32 v110, v111
  v_max3_f32 v110, v110, v111, v108
  v_sub_f32 v111, v108, v110
  v_mul_f32 v111, s35, v111
  v_exp_f32 v111, v111
  v_mov_b32 v108, v110
  v_mul_f32 v112, s35, v110
  v_fma_f32 v96, v96, s35, -v112
  v_exp_f32 v96, v96
  v_fma_f32 v97, v97, s35, -v112
  v_exp_f32 v97, v97
  v_fma_f32 v98, v98, s35, -v112
  v_exp_f32 v98, v98
  v_fma_f32 v99, v99, s35, -v112
  v_exp_f32 v99, v99
  v_fma_f32 v100, v100, s35, -v112
  v_exp_f32 v100, v100
  v_fma_f32 v101, v101, s35, -v112
  v_exp_f32 v101, v101
  v_fma_f32 v102, v102, s35, -v112
  v_exp_f32 v102, v102
  v_fma_f32 v103, v103, s35, -v112
  v_exp_f32 v103, v103
  s_nop 0
  v_mul_f32 v109, v109, v111
  v_add_f32 v109, v109, v96
  v_add_f32 v109, v109, v97
  v_add_f32 v109, v109, v98
  v_add_f32 v109, v109, v99
  v_add_f32 v109, v109, v100
  v_add_f32 v109, v109, v101
  v_add_f32 v109, v109, v102
  v_add_f32 v109, v109, v103
  v_cvt_pk_bf16_f32 v104, v96, v97
  v_cvt_pk_bf16_f32 v105, v98, v99
  v_cvt_pk_bf16_f32 v106, v100, v101
  v_cvt_pk_bf16_f32 v107, v102, v103
  v_readlane_b32 s50, v111, 0
  v_readlane_b32 s51, v111, 1
  v_readlane_b32 s52, v111, 2
  v_readlane_b32 s53, v111, 3
  s_nop 1
  v_mul_f32 v160, s50, v160
  v_mul_f32 v161, s51, v161
  v_mul_f32 v162, s52, v162
  v_mul_f32 v163, s53, v163
  v_mul_f32 v164, s50, v164
  v_mul_f32 v165, s51, v165
  v_mul_f32 v166, s52, v166
  v_mul_f32 v167, s53, v167
  v_mul_f32 v168, s50, v168
  v_mul_f32 v169, s51, v169
  v_mul_f32 v170, s52, v170
  v_mul_f32 v171, s53, v171
  v_mul_f32 v172, s50, v172
  v_mul_f32 v173, s51, v173
  v_mul_f32 v174, s52, v174
  v_mul_f32 v175, s53, v175
  v_mul_f32 v176, s50, v176
  v_mul_f32 v177, s51, v177
  v_mul_f32 v178, s52, v178
  v_mul_f32 v179, s53, v179
  v_mul_f32 v180, s50, v180
  v_mul_f32 v181, s51, v181
  v_mul_f32 v182, s52, v182
  v_mul_f32 v183, s53, v183
  v_mul_f32 v184, s50, v184
  v_mul_f32 v185, s51, v185
  v_mul_f32 v186, s52, v186
  v_mul_f32 v187, s53, v187
  v_mul_f32 v188, s50, v188
  v_mul_f32 v189, s51, v189
  v_mul_f32 v190, s52, v190
  v_mul_f32 v191, s53, v191
  s_waitcnt lgkmcnt(0)
  s_nop 1
  v_mfma_f32_16x16x32_bf16 v[160:163], v[104:107], v[128:131], v[160:163]
  v_mfma_f32_16x16x32_bf16 v[164:167], v[104:107], v[132:135], v[164:167]
  v_mfma_f32_16x16x32_bf16 v[168:171], v[104:107], v[136:139], v[168:171]
  v_mfma_f32_16x16x32_bf16 v[172:175], v[104:107], v[140:143], v[172:175]
  v_mfma_f32_16x16x32_bf16 v[176:179], v[104:107], v[144:147], v[176:179]
  v_mfma_f32_16x16x32_bf16 v[180:183], v[104:107], v[148:151], v[180:183]
  v_mfma_f32_16x16x32_bf16 v[184:187], v[104:107], v[152:155], v[184:187]
  v_mfma_f32_16x16x32_bf16 v[188:191], v[104:107], v[156:159], v[188:191]
  s_nop 7
  buffer_load_dwordx4 v[64:67], v2, s[20:23], s46 offen offset:0 nt
  buffer_load_dwordx4 v[68:71], v2, s[20:23], s46 offen offset:64 nt
  buffer_load_dwordx4 v[72:75], v2, s[20:23], s46 offen offset:128 nt
  buffer_load_dwordx4 v[76:79], v2, s[20:23], s46 offen offset:192 nt
  buffer_load_dwordx4 v[80:83], v2, s[20:23], s47 offen offset:0 nt
  buffer_load_dwordx4 v[84:87], v2, s[20:23], s47 offen offset:64 nt
  buffer_load_dwordx4 v[88:91], v2, s[20:23], s47 offen offset:128 nt
  buffer_load_dwordx4 v[92:95], v2, s[20:23], s47 offen offset:192 nt
  s_add_u32 s34, s33, 8192
  s_mov_b32 m0, s34
  s_nop 0
  buffer_load_dwordx4 v3, s[24:27], s46 offen offset:0 nt lds
  buffer_load_dwordx4 v4, s[24:27], s46 offen offset:1024 nt lds
  buffer_load_dwordx4 v3, s[24:27], s46 offen offset:2048 nt lds
  buffer_load_dwordx4 v4, s[24:27], s46 offen offset:3072 nt lds
  s_add_u32 s34, s33, 12288
  s_mov_b32 m0, s34
  s_nop 0
  buffer_load_dwordx4 v3, s[24:27], s47 offen offset:0 nt lds
  buffer_load_dwordx4 v4, s[24:27], s47 offen offset:1024 nt lds
  buffer_load_dwordx4 v3, s[24:27], s47 offen offset:2048 nt lds
  buffer_load_dwordx4 v4, s[24:27], s47 offen offset:3072 nt lds
  s_waitcnt vmcnt(16)
  v_mov_b32 v96, 0
  v_mov_b32 v97, 0
  v_mov_b32 v98, 0
  v_mov_b32 v99, 0
  v_mov_b32 v100, 0
  v_mov_b32 v101, 0
  v_mov_b32 v102, 0
  v_mov_b32 v103, 0
  s_nop 1
  v_mfma_f32_16x16x32_bf16 v[96:99], v[32:35], v[16:19], v[96:99]
  v_mfma_f32_16x16x32_bf16 v[96:99], v[36:39], v[20:23], v[96:99]
  v_mfma_f32_16x16x32_bf16 v[96:99], v[40:43], v[24:27], v[96:99]
  v_mfma_f32_16x16x32_bf16 v[96:99], v[44:47], v[28:31], v[96:99]
  v_mfma_f32_16x16x32_bf16 v[100:103], v[48:51], v[16:19], v[100:103]
  v_mfma_f32_16x16x32_bf16 v[100:103], v[52:55], v[20:23], v[100:103]
  v_mfma_f32_16x16x32_bf16 v[100:103], v[56:59], v[24:27], v[100:103]
  v_mfma_f32_16x16x32_bf16 v[100:103], v[60:63], v[28:31], v[100:103]
  ds_read_b64_tr_b16 v[128:129], v8 offset:0
  ds_read_b64_tr_b16 v[130:131], v8 offset:4096
  ds_read_b64_tr_b16 v[132:133], v9 offset:0
  ds_read_b64_tr_b16 v[134:135], v9 offset:4096
  ds_read_b64_tr_b16 v[136:137], v10 offset:0
  ds_read_b64_tr_b16 v[138:139], v10 offset:4096
  ds_read_b64_tr_b16 v[140:141], v11 offset:0
  ds_read_b64_tr_b16 v[142:143], v11 offset:4096
  ds_read_b64_tr_b16 v[144:145], v12 offset:0
  ds_read_b64_tr_b16 v[146:147], v12 offset:4096
  ds_read_b64_tr_b16 v[148:149], v13 offset:0
  ds_read_b64_tr_b16 v[150:151], v13 offset:4096
  ds_read_b64_tr_b16 v[152:153], v14 offset:0
  ds_read_b64_tr_b16 v[154:155], v14 offset:4096
  ds_read_b64_tr_b16 v[156:157], v15 offset:0
  ds_read_b64_tr_b16 v[158:159], v15 offset:4096
  s_nop 7
  v_max3_f32 v110, v96, v97, v98
  v_max3_f32 v111, v99, v100, v101
  v_max3_f32 v110, v110, v102, v103
  v_max_f32 v110, v110, v111
  v_mov_b32 v111, v110
  s_nop 1
  v_permlane16_swap_b32 v110, v111
  v_max_f32 v110, v110, v111
  v_mov_b32 v111, v110
  s_nop 1
  v_permlane32_swap_b32 v110, v111
  v_max3_f32 v110, v110, v111, v108
  v_sub_f32 v111, v108, v110
  v_mul_f32 v111, s35, v111
  v_exp_f32 v111, v111
  v_mov_b32 v108, v110
  v_mul_f32 v112, s35, v110
  v_fma_f32 v96, v96, s35, -v112
  v_exp_f32 v96, v96
  v_fma_f32 v97, v97, s35, -v112
  v_exp_f32 v97, v97
  v_fma_f32 v98, v98, s35, -v112
  v_exp_f32 v98, v98
  v_fma_f32 v99, v99, s35, -v112
  v_exp_f32 v99, v99
  v_fma_f32 v100, v100, s35, -v112
  v_exp_f32 v100, v100
  v_fma_f32 v101, v101, s35, -v112
  v_exp_f32 v101, v101
  v_fma_f32 v102, v102, s35, -v112
  v_exp_f32 v102, v102
  v_fma_f32 v103, v103, s35, -v112
  v_exp_f32 v103, v103
  s_nop 0
  v_mul_f32 v109, v109, v111
  v_add_f32 v109, v109, v96
  v_add_f32 v109, v109, v97
  v_add_f32 v109, v109, v98
  v_add_f32 v109, v109, v99
  v_add_f32 v109, v109, v100
  v_add_f32 v109, v109, v101
  v_add_f32 v109, v109, v102
  v_add_f32 v109, v109, v103
  v_cvt_pk_bf16_f32 v104, v96, v97
  v_cvt_pk_bf16_f32 v105, v98, v99
  v_cvt_pk_bf16_f32 v106, v100, v101
  v_cvt_pk_bf16_f32 v107, v102, v103
  v_readlane_b32 s50, v111, 0
  v_readlane_b32 s51, v111, 1
  v_readlane_b32 s52, v111, 2
  v_readlane_b32 s53, v111, 3
  s_nop 1
  v_mul_f32 v160, s50, v160
  v_mul_f32 v161, s51, v161
  v_mul_f32 v162, s52, v162
  v_mul_f32 v163, s53, v163
  v_mul_f32 v164, s50, v164
  v_mul_f32 v165, s51, v165
  v_mul_f32 v166, s52, v166
  v_mul_f32 v167, s53, v167
  v_mul_f32 v168, s50, v168
  v_mul_f32 v169, s51, v169
  v_mul_f32 v170, s52, v170
  v_mul_f32 v171, s53, v171
  v_mul_f32 v172, s50, v172
  v_mul_f32 v173, s51, v173
  v_mul_f32 v174, s52, v174
  v_mul_f32 v175, s53, v175
  v_mul_f32 v176, s50, v176
  v_mul_f32 v177, s51, v177
  v_mul_f32 v178, s52, v178
  v_mul_f32 v179, s53, v179
  v_mul_f32 v180, s50, v180
  v_mul_f32 v181, s51, v181
  v_mul_f32 v182, s52, v182
  v_mul_f32 v183, s53, v183
  v_mul_f32 v184, s50, v184
  v_mul_f32 v185, s51, v185
  v_mul_f32 v186, s52, v186
  v_mul_f32 v187, s53, v187
  v_mul_f32 v188, s50, v188
  v_mul_f32 v189, s51, v189
  v_mul_f32 v190, s52, v190
  v_mul_f32 v191, s53, v191
  s_waitcnt lgkmcnt(0)
  s_nop 1
  v_mfma_f32_16x16x32_bf16 v[160:163], v[104:107], v[128:131], v[160:163]
  v_mfma_f32_16x16x32_bf16 v[164:167], v[104:107], v[132:135], v[164:167]
  v_mfma_f32_16x16x32_bf16 v[168:171], v[104:107], v[136:139], v[168:171]
  v_mfma_f32_16x16x32_bf16 v[172:175], v[104:107], v[140:143], v[172:175]
  v_mfma_f32_16x16x32_bf16 v[176:179], v[104:107], v[144:147], v[176:179]
  v_mfma_f32_16x16x32_bf16 v[180:183], v[104:107], v[148:151], v[180:183]
  v_mfma_f32_16x16x32_bf16 v[184:187], v[104:107], v[152:155], v[184:187]
  v_mfma_f32_16x16x32_bf16 v[188:191], v[104:107], v[156:159], v[188:191]
  s_waitcnt vmcnt(0)
  v_mov_b32 v96, 0
  v_mov_b32 v97, 0
  v_mov_b32 v98, 0
  v_mov_b32 v99, 0
  v_mov_b32 v100, 0
  v_mov_b32 v101, 0
  v_mov_b32 v102, 0
  v_mov_b32 v103, 0
  s_nop 1
  v_mfma_f32_16x16x32_bf16 v[96:99], v[64:67], v[16:19], v[96:99]
  v_mfma_f32_16x16x32_bf16 v[96:99], v[68:71], v[20:23], v[96:99]
  v_mfma_f32_16x16x32_bf16 v[96:99], v[72:75], v[24:27], v[96:99]
  v_mfma_f32_16x16x32_bf16 v[96:99], v[76:79], v[28:31], v[96:99]
  v_mfma_f32_16x16x32_bf16 v[100:103], v[80:83], v[16:19], v[100:103]
  v_mfma_f32_16x16x32_bf16 v[100:103], v[84:87], v[20:23], v[100:103]
  v_mfma_f32_16x16x32_bf16 v[100:103], v[88:91], v[24:27], v[100:103]
  v_mfma_f32_16x16x32_bf16 v[100:103], v[92:95], v[28:31], v[100:103]
  ds_read_b64_tr_b16 v[128:129], v8 offset:8192
  ds_read_b64_tr_b16 v[130:131], v8 offset:12288
  ds_read_b64_tr_b16 v[132:133], v9 offset:8192
  ds_read_b64_tr_b16 v[134:135], v9 offset:12288
  ds_read_b64_tr_b16 v[136:137], v10 offset:8192
  ds_read_b64_tr_b16 v[138:139], v10 offset:12288
  ds_read_b64_tr_b16 v[140:141], v11 offset:8192
  ds_read_b64_tr_b16 v[142:143], v11 offset:12288
  ds_read_b64_tr_b16 v[144:145], v12 offset:8192
  ds_read_b64_tr_b16 v[146:147], v12 offset:12288
  ds_read_b64_tr_b16 v[148:149], v13 offset:8192
  ds_read_b64_tr_b16 v[150:151], v13 offset:12288
  ds_read_b64_tr_b16 v[152:153], v14 offset:8192
  ds_read_b64_tr_b16 v[154:155], v14 offset:12288
  ds_read_b64_tr_b16 v[156:157], v15 offset:8192
  ds_read_b64_tr_b16 v[158:159], v15 offset:12288
  s_nop 7
  v_max3_f32 v110, v96, v97, v98
  v_max3_f32 v111, v99, v100, v101
  v_max3_f32 v110, v110, v102, v103
  v_max_f32 v110, v110, v111
  v_mov_b32 v111, v110
  s_nop 1
  v_permlane16_swap_b32 v110, v111
  v_max_f32 v110, v110, v111
  v_mov_b32 v111, v110
  s_nop 1
  v_permlane32_swap_b32 v110, v111
  v_max3_f32 v110, v110, v111, v108
  v_sub_f32 v111, v108, v110
  v_mul_f32 v111, s35, v111
  v_exp_f32 v111, v111
  v_mov_b32 v108, v110
  v_mul_f32 v112, s35, v110
  v_fma_f32 v96, v96, s35, -v112
  v_exp_f32 v96, v96
  v_fma_f32 v97, v97, s35, -v112
  v_exp_f32 v97, v97
  v_fma_f32 v98, v98, s35, -v112
  v_exp_f32 v98, v98
  v_fma_f32 v99, v99, s35, -v112
  v_exp_f32 v99, v99
  v_fma_f32 v100, v100, s35, -v112
  v_exp_f32 v100, v100
  v_fma_f32 v101, v101, s35, -v112
  v_exp_f32 v101, v101
  v_fma_f32 v102, v102, s35, -v112
  v_exp_f32 v102, v102
  v_fma_f32 v103, v103, s35, -v112
  v_exp_f32 v103, v103
  s_nop 0
  v_mul_f32 v109, v109, v111
  v_add_f32 v109, v109, v96
  v_add_f32 v109, v109, v97
  v_add_f32 v109, v109, v98
  v_add_f32 v109, v109, v99
  v_add_f32 v109, v109, v100
  v_add_f32 v109, v109, v101
  v_add_f32 v109, v109, v102
  v_add_f32 v109, v109, v103
  v_cvt_pk_bf16_f32 v104, v96, v97
  v_cvt_pk_bf16_f32 v105, v98, v99
  v_cvt_pk_bf16_f32 v106, v100, v101
  v_cvt_pk_bf16_f32 v107, v102, v103
  v_readlane_b32 s50, v111, 0
  v_readlane_b32 s51, v111, 1
  v_readlane_b32 s52, v111, 2
  v_readlane_b32 s53, v111, 3
  s_nop 1
  v_mul_f32 v160, s50, v160
  v_mul_f32 v161, s51, v161
  v_mul_f32 v162, s52, v162
  v_mul_f32 v163, s53, v163
  v_mul_f32 v164, s50, v164
  v_mul_f32 v165, s51, v165
  v_mul_f32 v166, s52, v166
  v_mul_f32 v167, s53, v167
  v_mul_f32 v168, s50, v168
  v_mul_f32 v169, s51, v169
  v_mul_f32 v170, s52, v170
  v_mul_f32 v171, s53, v171
  v_mul_f32 v172, s50, v172
  v_mul_f32 v173, s51, v173
  v_mul_f32 v174, s52, v174
  v_mul_f32 v175, s53, v175
  v_mul_f32 v176, s50, v176
  v_mul_f32 v177, s51, v177
  v_mul_f32 v178, s52, v178
  v_mul_f32 v179, s53, v179
  v_mul_f32 v180, s50, v180
  v_mul_f32 v181, s51, v181
  v_mul_f32 v182, s52, v182
  v_mul_f32 v183, s53, v183
  v_mul_f32 v184, s50, v184
  v_mul_f32 v185, s51, v185
  v_mul_f32 v186, s52, v186
  v_mul_f32 v187, s53, v187
  v_mul_f32 v188, s50, v188
  v_mul_f32 v189, s51, v189
  v_mul_f32 v190, s52, v190
  v_mul_f32 v191, s53, v191
  s_waitcnt lgkmcnt(0)
  s_nop 1
  v_mfma_f32_16x16x32_bf16 v[160:163], v[104:107], v[128:131], v[160:163]
  v_mfma_f32_16x16x32_bf16 v[164:167], v[104:107], v[132:135], v[164:167]
  v_mfma_f32_16x16x32_bf16 v[168:171], v[104:107], v[136:139], v[168:171]
  v_mfma_f32_16x16x32_bf16 v[172:175], v[104:107], v[140:143], v[172:175]
  v_mfma_f32_16x16x32_bf16 v[176:179], v[104:107], v[144:147], v[176:179]
  v_mfma_f32_16x16x32_bf16 v[180:183], v[104:107], v[148:151], v[180:183]
  v_mfma_f32_16x16x32_bf16 v[184:187], v[104:107], v[152:155], v[184:187]
  v_mfma_f32_16x16x32_bf16 v[188:191], v[104:107], v[156:159], v[188:191]

  s_nop 7
  s_nop 7
  v_mov_b32 v111, v109
  s_nop 1
  v_permlane16_swap_b32 v109, v111
  v_add_f32 v109, v109, v111
  v_mov_b32 v111, v109
  s_nop 1
  v_permlane32_swap_b32 v109, v111
  v_add_f32 v109, v109, v111
  s_mul_i32 s34, s3, 2080
  s_add_u32 s34, s34, 131072
  v_lshl_add_u32 v5, v1, 2, s34
  v_cmp_gt_u32 vcc, 16, v1
  s_and_saveexec_b64 s[36:37], vcc

  ds_write_b32 v5, v160 offset:0
  ds_write_b32 v5, v161 offset:512
  ds_write_b32 v5, v162 offset:1024
  ds_write_b32 v5, v163 offset:1536
  ds_write_b32 v5, v164 offset:64
  ds_write_b32 v5, v165 offset:576
  ds_write_b32 v5, v166 offset:1088
  ds_write_b32 v5, v167 offset:1600
  ds_write_b32 v5, v168 offset:128
  ds_write_b32 v5, v169 offset:640
  ds_write_b32 v5, v170 offset:1152
  ds_write_b32 v5, v171 offset:1664
  ds_write_b32 v5, v172 offset:192
  ds_write_b32 v5, v173 offset:704
  ds_write_b32 v5, v174 offset:1216
  ds_write_b32 v5, v175 offset:1728
  ds_write_b32 v5, v176 offset:256
  ds_write_b32 v5, v177 offset:768
  ds_write_b32 v5, v178 offset:1280
  ds_write_b32 v5, v179 offset:1792
  ds_write_b32 v5, v180 offset:320
  ds_write_b32 v5, v181 offset:832
  ds_write_b32 v5, v182 offset:1344
  ds_write_b32 v5, v183 offset:1856
  ds_write_b32 v5, v184 offset:384
  ds_write_b32 v5, v185 offset:896
  ds_write_b32 v5, v186 offset:1408
  ds_write_b32 v5, v187 offset:1920
  ds_write_b32 v5, v188 offset:448
  ds_write_b32 v5, v189 offset:960
  ds_write_b32 v5, v190 offset:1472
  ds_write_b32 v5, v191 offset:1984

  v_cmp_gt_u32 vcc, 4, v1
  s_and_b64 exec, exec, vcc
  ds_write_b32 v5, v108 offset:2048
  ds_write_b32 v5, v109 offset:2064
  s_mov_b64 exec, s[36:37]
  s_waitcnt lgkmcnt(0)
  s_barrier
  v_lshlrev_b32 v5, 2, v0
  v_add_u32 v5, 131072, v5
  v_lshrrev_b32 v6, 7, v0
  v_lshlrev_b32 v6, 2, v6
  v_add_u32 v6, 133120, v6

  ds_read_b32 v16, v5 offset:0
  ds_read_b32 v24, v6 offset:0
  ds_read_b32 v32, v6 offset:16
  ds_read_b32 v17, v5 offset:2080
  ds_read_b32 v25, v6 offset:2080
  ds_read_b32 v33, v6 offset:2096
  ds_read_b32 v18, v5 offset:4160
  ds_read_b32 v26, v6 offset:4160
  ds_read_b32 v34, v6 offset:4176
  ds_read_b32 v19, v5 offset:6240
  ds_read_b32 v27, v6 offset:6240
  ds_read_b32 v35, v6 offset:6256
  ds_read_b32 v20, v5 offset:8320
  ds_read_b32 v28, v6 offset:8320
  ds_read_b32 v36, v6 offset:8336
  ds_read_b32 v21, v5 offset:10400
  ds_read_b32 v29, v6 offset:10400
  ds_read_b32 v37, v6 offset:10416
  ds_read_b32 v22, v5 offset:12480
  ds_read_b32 v30, v6 offset:12480
  ds_read_b32 v38, v6 offset:12496
  ds_read_b32 v23, v5 offset:14560
  ds_read_b32 v31, v6 offset:14560
  ds_read_b32 v39, v6 offset:14576
  s_waitcnt lgkmcnt(0)
  v_max3_f32 v40, v24, v25, v26
  v_max3_f32 v40, v40, v27, v28
  v_max3_f32 v40, v40, v29, v30
  v_max_f32 v40, v40, v31
  v_mov_b32 v41, 0
  v_mov_b32 v42, 0
  v_sub_f32 v43, v24, v40
  v_mul_f32 v43, s35, v43
  v_exp_f32 v43, v43
  s_nop 0
  v_fmac_f32 v41, v43, v16
  v_fmac_f32 v42, v43, v32
  v_sub_f32 v43, v25, v40
  v_mul_f32 v43, s35, v43
  v_exp_f32 v43, v43
  s_nop 0
  v_fmac_f32 v41, v43, v17
  v_fmac_f32 v42, v43, v33
  v_sub_f32 v43, v26, v40
  v_mul_f32 v43, s35, v43
  v_exp_f32 v43, v43
  s_nop 0
  v_fmac_f32 v41, v43, v18
  v_fmac_f32 v42, v43, v34
  v_sub_f32 v43, v27, v40
  v_mul_f32 v43, s35, v43
  v_exp_f32 v43, v43
  s_nop 0
  v_fmac_f32 v41, v43, v19
  v_fmac_f32 v42, v43, v35
  v_sub_f32 v43, v28, v40
  v_mul_f32 v43, s35, v43
  v_exp_f32 v43, v43
  s_nop 0
  v_fmac_f32 v41, v43, v20
  v_fmac_f32 v42, v43, v36
  v_sub_f32 v43, v29, v40
  v_mul_f32 v43, s35, v43
  v_exp_f32 v43, v43
  s_nop 0
  v_fmac_f32 v41, v43, v21
  v_fmac_f32 v42, v43, v37
  v_sub_f32 v43, v30, v40
  v_mul_f32 v43, s35, v43
  v_exp_f32 v43, v43
  s_nop 0
  v_fmac_f32 v41, v43, v22
  v_fmac_f32 v42, v43, v38
  v_sub_f32 v43, v31, v40
  v_mul_f32 v43, s35, v43
  v_exp_f32 v43, v43
  s_nop 0
  v_fmac_f32 v41, v43, v23
  v_fmac_f32 v42, v43, v39

  s_lshl_b32 s16, s14, 5
  s_add_u32 s16, s16, s15
  s_lshl_b32 s17, s16, 11
  s_add_u32 s17, s17, 65536
  v_lshl_add_u32 v5, v0, 2, s17
  global_store_dword v5, v41, s[12:13]
  v_and_b32 v6, 127, v0
  v_cmp_eq_u32 vcc, 0, v6
  s_and_saveexec_b64 s[36:37], vcc
  s_lshl_b32 s17, s16, 5
  s_add_u32 s17, s17, 32768
  v_lshrrev_b32 v6, 5, v0
  v_add_u32 v6, s17, v6
  global_store_dword v6, v40, s[12:13]
  global_store_dword v6, v42, s[12:13] offset:16
k2_end:
  s_endpgm

.section .rodata,"a"
.p2align 6
.amdhsa_kernel k2_kernel
  .amdhsa_next_free_vgpr 192
  .amdhsa_next_free_sgpr 64
  .amdhsa_accum_offset 192
  .amdhsa_group_segment_fixed_size 0
  .amdhsa_kernarg_size 104
  .amdhsa_user_sgpr_count 2
  .amdhsa_user_sgpr_kernarg_segment_ptr 1
  .amdhsa_system_sgpr_workgroup_id_x 1
.end_amdhsa_kernel
.text
.globl k3_kernel
.p2align 8
.type k3_kernel,@function
k3_kernel:

  s_cmp_ge_u32 s2, 80
  s_cbranch_scc1 k3_end
  s_load_dwordx2 s[4:5], s[0:1], 0
  s_load_dwordx2 s[6:7], s[0:1], 32
  s_load_dwordx2 s[8:9], s[0:1], 64
  s_load_dwordx2 s[10:11], s[0:1], 72
  s_load_dwordx2 s[12:13], s[0:1], 96
  s_load_dwordx2 s[14:15], s[0:1], 80
  s_load_dwordx2 s[16:17], s[0:1], 88
  s_mov_b32 s35, 0x3e0293ee
  s_cmp_ge_u32 s2, 64
  s_waitcnt lgkmcnt(0)
  s_cbranch_scc1 k3_g
  s_and_b32 s18, s2, 7
  s_lshr_b32 s19, s2, 3
  s_mov_b32 s24, s6
  s_mov_b32 s25, s7
  s_mov_b32 s26, 0x400000
  s_mov_b32 s27, 0x00020000
  v_lshrrev_b32 v4, 3, v0
  v_lshlrev_b32 v5, 10, v4
  v_and_b32 v6, 7, v0
  v_lshl_add_u32 v5, v6, 4, v5
  s_lshl_b32 s20, s19, 19
  s_lshl_b32 s21, s18, 7
  s_add_u32 s20, s20, s21

  buffer_load_dwordx4 v[64:67], v5, s[24:27], s20 offen
  s_add_u32 s20, s20, 0x8000
  buffer_load_dwordx4 v[68:71], v5, s[24:27], s20 offen
  s_add_u32 s20, s20, 0x8000
  buffer_load_dwordx4 v[72:75], v5, s[24:27], s20 offen
  s_add_u32 s20, s20, 0x8000
  buffer_load_dwordx4 v[76:79], v5, s[24:27], s20 offen
  s_add_u32 s20, s20, 0x8000
  buffer_load_dwordx4 v[80:83], v5, s[24:27], s20 offen
  s_add_u32 s20, s20, 0x8000
  buffer_load_dwordx4 v[84:87], v5, s[24:27], s20 offen
  s_add_u32 s20, s20, 0x8000
  buffer_load_dwordx4 v[88:91], v5, s[24:27], s20 offen
  s_add_u32 s20, s20, 0x8000
  buffer_load_dwordx4 v[92:95], v5, s[24:27], s20 offen
  s_add_u32 s20, s20, 0x8000
  buffer_load_dwordx4 v[96:99], v5, s[24:27], s20 offen
  s_add_u32 s20, s20, 0x8000
  buffer_load_dwordx4 v[100:103], v5, s[24:27], s20 offen
  s_add_u32 s20, s20, 0x8000
  buffer_load_dwordx4 v[104:107], v5, s[24:27], s20 offen
  s_add_u32 s20, s20, 0x8000
  buffer_load_dwordx4 v[108:111], v5, s[24:27], s20 offen
  s_add_u32 s20, s20, 0x8000
  buffer_load_dwordx4 v[112:115], v5, s[24:27], s20 offen
  s_add_u32 s20, s20, 0x8000
  buffer_load_dwordx4 v[116:119], v5, s[24:27], s20 offen
  s_add_u32 s20, s20, 0x8000
  buffer_load_dwordx4 v[120:123], v5, s[24:27], s20 offen
  s_add_u32 s20, s20, 0x8000
  buffer_load_dwordx4 v[124:127], v5, s[24:27], s20 offen
  s_add_u32 s20, s20, 0x8000

  s_lshl_b32 s20, s19, 10
  s_add_u32 s20, s20, 32768
  v_lshl_add_u32 v7, v0, 2, s20
  global_load_dword v8, v7, s[12:13]
  v_lshlrev_b32 v7, 2, v0
  s_waitcnt vmcnt(0)
  ds_write_b32 v7, v8 offset:9728
  s_lshl_b32 s20, s19, 16
  s_add_u32 s20, s20, 65536
  v_lshl_add_u32 v7, v0, 3, s20

  global_load_dwordx2 v[128:129], v7, s[12:13] offset:0
  v_add_u32 v7, 0x800, v7
  global_load_dwordx2 v[130:131], v7, s[12:13] offset:0
  v_add_u32 v7, 0x800, v7
  global_load_dwordx2 v[132:133], v7, s[12:13] offset:0
  v_add_u32 v7, 0x800, v7
  global_load_dwordx2 v[134:135], v7, s[12:13] offset:0
  v_add_u32 v7, 0x800, v7
  global_load_dwordx2 v[136:137], v7, s[12:13] offset:0
  v_add_u32 v7, 0x800, v7
  global_load_dwordx2 v[138:139], v7, s[12:13] offset:0
  v_add_u32 v7, 0x800, v7
  global_load_dwordx2 v[140:141], v7, s[12:13] offset:0
  v_add_u32 v7, 0x800, v7
  global_load_dwordx2 v[142:143], v7, s[12:13] offset:0
  v_add_u32 v7, 0x800, v7
  global_load_dwordx2 v[144:145], v7, s[12:13] offset:0
  v_add_u32 v7, 0x800, v7
  global_load_dwordx2 v[146:147], v7, s[12:13] offset:0
  v_add_u32 v7, 0x800, v7
  global_load_dwordx2 v[148:149], v7, s[12:13] offset:0
  v_add_u32 v7, 0x800, v7
  global_load_dwordx2 v[150:151], v7, s[12:13] offset:0
  v_add_u32 v7, 0x800, v7
  global_load_dwordx2 v[152:153], v7, s[12:13] offset:0
  v_add_u32 v7, 0x800, v7
  global_load_dwordx2 v[154:155], v7, s[12:13] offset:0
  v_add_u32 v7, 0x800, v7
  global_load_dwordx2 v[156:157], v7, s[12:13] offset:0
  v_add_u32 v7, 0x800, v7
  global_load_dwordx2 v[158:159], v7, s[12:13] offset:0
  v_add_u32 v7, 0x800, v7
  global_load_dwordx2 v[160:161], v7, s[12:13] offset:0
  v_add_u32 v7, 0x800, v7
  global_load_dwordx2 v[162:163], v7, s[12:13] offset:0
  v_add_u32 v7, 0x800, v7
  global_load_dwordx2 v[164:165], v7, s[12:13] offset:0
  v_add_u32 v7, 0x800, v7
  global_load_dwordx2 v[166:167], v7, s[12:13] offset:0
  v_add_u32 v7, 0x800, v7
  global_load_dwordx2 v[168:169], v7, s[12:13] offset:0
  v_add_u32 v7, 0x800, v7
  global_load_dwordx2 v[170:171], v7, s[12:13] offset:0
  v_add_u32 v7, 0x800, v7
  global_load_dwordx2 v[172:173], v7, s[12:13] offset:0
  v_add_u32 v7, 0x800, v7
  global_load_dwordx2 v[174:175], v7, s[12:13] offset:0
  v_add_u32 v7, 0x800, v7
  global_load_dwordx2 v[176:177], v7, s[12:13] offset:0
  v_add_u32 v7, 0x800, v7
  global_load_dwordx2 v[178:179], v7, s[12:13] offset:0
  v_add_u32 v7, 0x800, v7
  global_load_dwordx2 v[180:181], v7, s[12:13] offset:0
  v_add_u32 v7, 0x800, v7
  global_load_dwordx2 v[182:183], v7, s[12:13] offset:0
  v_add_u32 v7, 0x800, v7
  global_load_dwordx2 v[184:185], v7, s[12:13] offset:0
  v_add_u32 v7, 0x800, v7
  global_load_dwordx2 v[186:187], v7, s[12:13] offset:0
  v_add_u32 v7, 0x800, v7
  global_load_dwordx2 v[188:189], v7, s[12:13] offset:0
  v_add_u32 v7, 0x800, v7
  global_load_dwordx2 v[190:191], v7, s[12:13] offset:0
  v_add_u32 v7, 0x800, v7

  s_waitcnt lgkmcnt(0)
  s_barrier
  v_lshrrev_b32 v7, 6, v0
  v_lshlrev_b32 v7, 2, v7
  v_mov_b32 v9, 0xff800000

  ds_read_b32 v32, v7 offset:9728
  ds_read_b32 v33, v7 offset:9760
  ds_read_b32 v34, v7 offset:9792
  ds_read_b32 v35, v7 offset:9824
  ds_read_b32 v36, v7 offset:9856
  ds_read_b32 v37, v7 offset:9888
  ds_read_b32 v38, v7 offset:9920
  ds_read_b32 v39, v7 offset:9952
  ds_read_b32 v40, v7 offset:9984
  ds_read_b32 v41, v7 offset:10016
  ds_read_b32 v42, v7 offset:10048
  ds_read_b32 v43, v7 offset:10080
  ds_read_b32 v44, v7 offset:10112
  ds_read_b32 v45, v7 offset:10144
  ds_read_b32 v46, v7 offset:10176
  ds_read_b32 v47, v7 offset:10208
  ds_read_b32 v48, v7 offset:10240
  ds_read_b32 v49, v7 offset:10272
  ds_read_b32 v50, v7 offset:10304
  ds_read_b32 v51, v7 offset:10336
  ds_read_b32 v52, v7 offset:10368
  ds_read_b32 v53, v7 offset:10400
  ds_read_b32 v54, v7 offset:10432
  ds_read_b32 v55, v7 offset:10464
  ds_read_b32 v56, v7 offset:10496
  ds_read_b32 v57, v7 offset:10528
  ds_read_b32 v58, v7 offset:10560
  ds_read_b32 v59, v7 offset:10592
  ds_read_b32 v60, v7 offset:10624
  ds_read_b32 v61, v7 offset:10656
  ds_read_b32 v62, v7 offset:10688
  ds_read_b32 v63, v7 offset:10720
  s_waitcnt lgkmcnt(0)
  v_max_f32 v9, v9, v32
  v_max_f32 v9, v9, v33
  v_max_f32 v9, v9, v34
  v_max_f32 v9, v9, v35
  v_max_f32 v9, v9, v36
  v_max_f32 v9, v9, v37
  v_max_f32 v9, v9, v38
  v_max_f32 v9, v9, v39
  v_max_f32 v9, v9, v40
  v_max_f32 v9, v9, v41
  v_max_f32 v9, v9, v42
  v_max_f32 v9, v9, v43
  v_max_f32 v9, v9, v44
  v_max_f32 v9, v9, v45
  v_max_f32 v9, v9, v46
  v_max_f32 v9, v9, v47
  v_max_f32 v9, v9, v48
  v_max_f32 v9, v9, v49
  v_max_f32 v9, v9, v50
  v_max_f32 v9, v9, v51
  v_max_f32 v9, v9, v52
  v_max_f32 v9, v9, v53
  v_max_f32 v9, v9, v54
  v_max_f32 v9, v9, v55
  v_max_f32 v9, v9, v56
  v_max_f32 v9, v9, v57
  v_max_f32 v9, v9, v58
  v_max_f32 v9, v9, v59
  v_max_f32 v9, v9, v60
  v_max_f32 v9, v9, v61
  v_max_f32 v9, v9, v62
  v_max_f32 v9, v9, v63
  v_mov_b32 v10, 0
  v_mov_b32 v11, 0
  v_mov_b32 v12, 0
  v_sub_f32 v32, v32, v9
  v_mul_f32 v32, s35, v32
  v_exp_f32 v32, v32
  ds_read_b32 v13, v7 offset:9744
  s_waitcnt lgkmcnt(0)
  v_fmac_f32 v10, v13, v32
  v_sub_f32 v33, v33, v9
  v_mul_f32 v33, s35, v33
  v_exp_f32 v33, v33
  ds_read_b32 v13, v7 offset:9776
  s_waitcnt lgkmcnt(0)
  v_fmac_f32 v10, v13, v33
  v_sub_f32 v34, v34, v9
  v_mul_f32 v34, s35, v34
  v_exp_f32 v34, v34
  ds_read_b32 v13, v7 offset:9808
  s_waitcnt lgkmcnt(0)
  v_fmac_f32 v10, v13, v34
  v_sub_f32 v35, v35, v9
  v_mul_f32 v35, s35, v35
  v_exp_f32 v35, v35
  ds_read_b32 v13, v7 offset:9840
  s_waitcnt lgkmcnt(0)
  v_fmac_f32 v10, v13, v35
  v_sub_f32 v36, v36, v9
  v_mul_f32 v36, s35, v36
  v_exp_f32 v36, v36
  ds_read_b32 v13, v7 offset:9872
  s_waitcnt lgkmcnt(0)
  v_fmac_f32 v10, v13, v36
  v_sub_f32 v37, v37, v9
  v_mul_f32 v37, s35, v37
  v_exp_f32 v37, v37
  ds_read_b32 v13, v7 offset:9904
  s_waitcnt lgkmcnt(0)
  v_fmac_f32 v10, v13, v37
  v_sub_f32 v38, v38, v9
  v_mul_f32 v38, s35, v38
  v_exp_f32 v38, v38
  ds_read_b32 v13, v7 offset:9936
  s_waitcnt lgkmcnt(0)
  v_fmac_f32 v10, v13, v38
  v_sub_f32 v39, v39, v9
  v_mul_f32 v39, s35, v39
  v_exp_f32 v39, v39
  ds_read_b32 v13, v7 offset:9968
  s_waitcnt lgkmcnt(0)
  v_fmac_f32 v10, v13, v39
  v_sub_f32 v40, v40, v9
  v_mul_f32 v40, s35, v40
  v_exp_f32 v40, v40
  ds_read_b32 v13, v7 offset:10000
  s_waitcnt lgkmcnt(0)
  v_fmac_f32 v10, v13, v40
  v_sub_f32 v41, v41, v9
  v_mul_f32 v41, s35, v41
  v_exp_f32 v41, v41
  ds_read_b32 v13, v7 offset:10032
  s_waitcnt lgkmcnt(0)
  v_fmac_f32 v10, v13, v41
  v_sub_f32 v42, v42, v9
  v_mul_f32 v42, s35, v42
  v_exp_f32 v42, v42
  ds_read_b32 v13, v7 offset:10064
  s_waitcnt lgkmcnt(0)
  v_fmac_f32 v10, v13, v42
  v_sub_f32 v43, v43, v9
  v_mul_f32 v43, s35, v43
  v_exp_f32 v43, v43
  ds_read_b32 v13, v7 offset:10096
  s_waitcnt lgkmcnt(0)
  v_fmac_f32 v10, v13, v43
  v_sub_f32 v44, v44, v9
  v_mul_f32 v44, s35, v44
  v_exp_f32 v44, v44
  ds_read_b32 v13, v7 offset:10128
  s_waitcnt lgkmcnt(0)
  v_fmac_f32 v10, v13, v44
  v_sub_f32 v45, v45, v9
  v_mul_f32 v45, s35, v45
  v_exp_f32 v45, v45
  ds_read_b32 v13, v7 offset:10160
  s_waitcnt lgkmcnt(0)
  v_fmac_f32 v10, v13, v45
  v_sub_f32 v46, v46, v9
  v_mul_f32 v46, s35, v46
  v_exp_f32 v46, v46
  ds_read_b32 v13, v7 offset:10192
  s_waitcnt lgkmcnt(0)
  v_fmac_f32 v10, v13, v46
  v_sub_f32 v47, v47, v9
  v_mul_f32 v47, s35, v47
  v_exp_f32 v47, v47
  ds_read_b32 v13, v7 offset:10224
  s_waitcnt lgkmcnt(0)
  v_fmac_f32 v10, v13, v47
  v_sub_f32 v48, v48, v9
  v_mul_f32 v48, s35, v48
  v_exp_f32 v48, v48
  ds_read_b32 v13, v7 offset:10256
  s_waitcnt lgkmcnt(0)
  v_fmac_f32 v10, v13, v48
  v_sub_f32 v49, v49, v9
  v_mul_f32 v49, s35, v49
  v_exp_f32 v49, v49
  ds_read_b32 v13, v7 offset:10288
  s_waitcnt lgkmcnt(0)
  v_fmac_f32 v10, v13, v49
  v_sub_f32 v50, v50, v9
  v_mul_f32 v50, s35, v50
  v_exp_f32 v50, v50
  ds_read_b32 v13, v7 offset:10320
  s_waitcnt lgkmcnt(0)
  v_fmac_f32 v10, v13, v50
  v_sub_f32 v51, v51, v9
  v_mul_f32 v51, s35, v51
  v_exp_f32 v51, v51
  ds_read_b32 v13, v7 offset:10352
  s_waitcnt lgkmcnt(0)
  v_fmac_f32 v10, v13, v51
  v_sub_f32 v52, v52, v9
  v_mul_f32 v52, s35, v52
  v_exp_f32 v52, v52
  ds_read_b32 v13, v7 offset:10384
  s_waitcnt lgkmcnt(0)
  v_fmac_f32 v10, v13, v52
  v_sub_f32 v53, v53, v9
  v_mul_f32 v53, s35, v53
  v_exp_f32 v53, v53
  ds_read_b32 v13, v7 offset:10416
  s_waitcnt lgkmcnt(0)
  v_fmac_f32 v10, v13, v53
  v_sub_f32 v54, v54, v9
  v_mul_f32 v54, s35, v54
  v_exp_f32 v54, v54
  ds_read_b32 v13, v7 offset:10448
  s_waitcnt lgkmcnt(0)
  v_fmac_f32 v10, v13, v54
  v_sub_f32 v55, v55, v9
  v_mul_f32 v55, s35, v55
  v_exp_f32 v55, v55
  ds_read_b32 v13, v7 offset:10480
  s_waitcnt lgkmcnt(0)
  v_fmac_f32 v10, v13, v55
  v_sub_f32 v56, v56, v9
  v_mul_f32 v56, s35, v56
  v_exp_f32 v56, v56
  ds_read_b32 v13, v7 offset:10512
  s_waitcnt lgkmcnt(0)
  v_fmac_f32 v10, v13, v56
  v_sub_f32 v57, v57, v9
  v_mul_f32 v57, s35, v57
  v_exp_f32 v57, v57
  ds_read_b32 v13, v7 offset:10544
  s_waitcnt lgkmcnt(0)
  v_fmac_f32 v10, v13, v57
  v_sub_f32 v58, v58, v9
  v_mul_f32 v58, s35, v58
  v_exp_f32 v58, v58
  ds_read_b32 v13, v7 offset:10576
  s_waitcnt lgkmcnt(0)
  v_fmac_f32 v10, v13, v58
  v_sub_f32 v59, v59, v9
  v_mul_f32 v59, s35, v59
  v_exp_f32 v59, v59
  ds_read_b32 v13, v7 offset:10608
  s_waitcnt lgkmcnt(0)
  v_fmac_f32 v10, v13, v59
  v_sub_f32 v60, v60, v9
  v_mul_f32 v60, s35, v60
  v_exp_f32 v60, v60
  ds_read_b32 v13, v7 offset:10640
  s_waitcnt lgkmcnt(0)
  v_fmac_f32 v10, v13, v60
  v_sub_f32 v61, v61, v9
  v_mul_f32 v61, s35, v61
  v_exp_f32 v61, v61
  ds_read_b32 v13, v7 offset:10672
  s_waitcnt lgkmcnt(0)
  v_fmac_f32 v10, v13, v61
  v_sub_f32 v62, v62, v9
  v_mul_f32 v62, s35, v62
  v_exp_f32 v62, v62
  ds_read_b32 v13, v7 offset:10704
  s_waitcnt lgkmcnt(0)
  v_fmac_f32 v10, v13, v62
  v_sub_f32 v63, v63, v9
  v_mul_f32 v63, s35, v63
  v_exp_f32 v63, v63
  ds_read_b32 v13, v7 offset:10736
  s_waitcnt lgkmcnt(0)
  v_fmac_f32 v10, v13, v63
  s_waitcnt vmcnt(0)
  v_fmac_f32 v11, v32, v128
  v_fmac_f32 v12, v32, v129
  v_fmac_f32 v11, v33, v130
  v_fmac_f32 v12, v33, v131
  v_fmac_f32 v11, v34, v132
  v_fmac_f32 v12, v34, v133
  v_fmac_f32 v11, v35, v134
  v_fmac_f32 v12, v35, v135
  v_fmac_f32 v11, v36, v136
  v_fmac_f32 v12, v36, v137
  v_fmac_f32 v11, v37, v138
  v_fmac_f32 v12, v37, v139
  v_fmac_f32 v11, v38, v140
  v_fmac_f32 v12, v38, v141
  v_fmac_f32 v11, v39, v142
  v_fmac_f32 v12, v39, v143
  v_fmac_f32 v11, v40, v144
  v_fmac_f32 v12, v40, v145
  v_fmac_f32 v11, v41, v146
  v_fmac_f32 v12, v41, v147
  v_fmac_f32 v11, v42, v148
  v_fmac_f32 v12, v42, v149
  v_fmac_f32 v11, v43, v150
  v_fmac_f32 v12, v43, v151
  v_fmac_f32 v11, v44, v152
  v_fmac_f32 v12, v44, v153
  v_fmac_f32 v11, v45, v154
  v_fmac_f32 v12, v45, v155
  v_fmac_f32 v11, v46, v156
  v_fmac_f32 v12, v46, v157
  v_fmac_f32 v11, v47, v158
  v_fmac_f32 v12, v47, v159
  v_fmac_f32 v11, v48, v160
  v_fmac_f32 v12, v48, v161
  v_fmac_f32 v11, v49, v162
  v_fmac_f32 v12, v49, v163
  v_fmac_f32 v11, v50, v164
  v_fmac_f32 v12, v50, v165
  v_fmac_f32 v11, v51, v166
  v_fmac_f32 v12, v51, v167
  v_fmac_f32 v11, v52, v168
  v_fmac_f32 v12, v52, v169
  v_fmac_f32 v11, v53, v170
  v_fmac_f32 v12, v53, v171
  v_fmac_f32 v11, v54, v172
  v_fmac_f32 v12, v54, v173
  v_fmac_f32 v11, v55, v174
  v_fmac_f32 v12, v55, v175
  v_fmac_f32 v11, v56, v176
  v_fmac_f32 v12, v56, v177
  v_fmac_f32 v11, v57, v178
  v_fmac_f32 v12, v57, v179
  v_fmac_f32 v11, v58, v180
  v_fmac_f32 v12, v58, v181
  v_fmac_f32 v11, v59, v182
  v_fmac_f32 v12, v59, v183
  v_fmac_f32 v11, v60, v184
  v_fmac_f32 v12, v60, v185
  v_fmac_f32 v11, v61, v186
  v_fmac_f32 v12, v61, v187
  v_fmac_f32 v11, v62, v188
  v_fmac_f32 v12, v62, v189
  v_fmac_f32 v11, v63, v190
  v_fmac_f32 v12, v63, v191

  v_rcp_f32 v10, v10
  s_nop 0
  v_mul_f32 v11, v11, v10
  v_mul_f32 v12, v12, v10
  RBF v11
  RBF v12
  v_lshlrev_b32 v7, 3, v0
  ds_write_b32 v7, v11 offset:0
  ds_write_b32 v7, v12 offset:4
  s_waitcnt lgkmcnt(0)
  s_barrier
  v_lshlrev_b32 v4, 2, v4

  ds_read_b32 v32, v4 offset:0
  ds_read_b32 v33, v4 offset:128
  ds_read_b32 v34, v4 offset:256
  ds_read_b32 v35, v4 offset:384
  ds_read_b32 v36, v4 offset:512
  ds_read_b32 v37, v4 offset:640
  ds_read_b32 v38, v4 offset:768
  ds_read_b32 v39, v4 offset:896
  ds_read_b32 v40, v4 offset:1024
  ds_read_b32 v41, v4 offset:1152
  ds_read_b32 v42, v4 offset:1280
  ds_read_b32 v43, v4 offset:1408
  ds_read_b32 v44, v4 offset:1536
  ds_read_b32 v45, v4 offset:1664
  ds_read_b32 v46, v4 offset:1792
  ds_read_b32 v47, v4 offset:1920
  v_mov_b32 v8, 0
  v_mov_b32 v9, 0
  v_mov_b32 v10, 0
  v_mov_b32 v11, 0
  v_mov_b32 v12, 0
  v_mov_b32 v13, 0
  v_mov_b32 v14, 0
  v_mov_b32 v15, 0
  s_waitcnt lgkmcnt(0)
  FMA8 8, 64, v32
  FMA8 8, 68, v33
  FMA8 8, 72, v34
  FMA8 8, 76, v35
  FMA8 8, 80, v36
  FMA8 8, 84, v37
  FMA8 8, 88, v38
  FMA8 8, 92, v39
  FMA8 8, 96, v40
  FMA8 8, 100, v41
  FMA8 8, 104, v42
  FMA8 8, 108, v43
  FMA8 8, 112, v44
  FMA8 8, 116, v45
  FMA8 8, 120, v46
  FMA8 8, 124, v47

  s_barrier
  v_lshlrev_b32 v16, 5, v0
  ds_write_b128 v16, v[8:11]
  ds_write_b128 v16, v[12:15] offset:16
  s_waitcnt lgkmcnt(0)
  s_barrier
  v_and_b32 v16, 63, v0
  v_lshrrev_b32 v17, 6, v0
  v_lshlrev_b32 v17, 11, v17
  v_lshl_add_u32 v16, v16, 2, v17

  ds_read_b32 v8, v16 offset:0
  ds_read_b32 v9, v16 offset:256
  ds_read_b32 v10, v16 offset:512
  ds_read_b32 v11, v16 offset:768
  ds_read_b32 v12, v16 offset:1024
  ds_read_b32 v13, v16 offset:1280
  ds_read_b32 v14, v16 offset:1536
  ds_read_b32 v15, v16 offset:1792

  s_waitcnt lgkmcnt(0)
  v_add_f32 v8, v8, v9
  v_add_f32 v10, v10, v11
  v_add_f32 v12, v12, v13
  v_add_f32 v14, v14, v15
  v_add_f32 v8, v8, v10
  v_add_f32 v12, v12, v14
  v_add_f32 v8, v8, v12
  v_lshlrev_b32 v16, 2, v0
  ds_write_b32 v16, v8 offset:8448
  s_waitcnt lgkmcnt(0)
  s_barrier
  v_cmp_gt_u32 vcc, 64, v0
  s_and_saveexec_b64 s[30:31], vcc
  s_cbranch_execz k3_end
  ds_read_b32 v8, v16 offset:8448
  ds_read_b32 v9, v16 offset:8704
  ds_read_b32 v10, v16 offset:8960
  ds_read_b32 v11, v16 offset:9216
  s_waitcnt lgkmcnt(0)
  v_add_f32 v8, v8, v9
  v_add_f32 v10, v10, v11
  v_add_f32 v8, v8, v10
  s_lshl_b32 s20, s19, 11
  s_lshl_b32 s21, s18, 8
  s_add_u32 s20, s20, s21
  s_add_u32 s20, s20, 1048576
  v_add_u32 v16, s20, v16
  global_store_dword v16, v8, s[12:13] sc1
  s_branch k3_arrive
k3_g:
  s_sub_u32 s18, s2, 64
  s_mov_b32 s24, s8
  s_mov_b32 s25, s9
  s_mov_b32 s26, 0x1c0000
  s_mov_b32 s27, 0x00020000
  v_lshrrev_b32 v4, 2, v0
  v_lshlrev_b32 v5, 10, v4
  v_and_b32 v6, 3, v0
  v_lshl_add_u32 v5, v6, 4, v5
  s_lshl_b32 s20, s18, 6

  buffer_load_dwordx4 v[64:67], v5, s[24:27], s20 offen
  s_add_u32 s20, s20, 0x10000
  buffer_load_dwordx4 v[68:71], v5, s[24:27], s20 offen
  s_add_u32 s20, s20, 0x10000
  buffer_load_dwordx4 v[72:75], v5, s[24:27], s20 offen
  s_add_u32 s20, s20, 0x10000
  buffer_load_dwordx4 v[76:79], v5, s[24:27], s20 offen
  s_add_u32 s20, s20, 0x10000
  buffer_load_dwordx4 v[80:83], v5, s[24:27], s20 offen
  s_add_u32 s20, s20, 0x10000
  buffer_load_dwordx4 v[84:87], v5, s[24:27], s20 offen
  s_add_u32 s20, s20, 0x10000
  buffer_load_dwordx4 v[88:91], v5, s[24:27], s20 offen
  s_add_u32 s20, s20, 0x10000
  buffer_load_dwordx4 v[92:95], v5, s[24:27], s20 offen
  s_add_u32 s20, s20, 0x10000
  buffer_load_dwordx4 v[96:99], v5, s[24:27], s20 offen
  s_add_u32 s20, s20, 0x10000
  buffer_load_dwordx4 v[100:103], v5, s[24:27], s20 offen
  s_add_u32 s20, s20, 0x10000
  buffer_load_dwordx4 v[104:107], v5, s[24:27], s20 offen
  s_add_u32 s20, s20, 0x10000
  buffer_load_dwordx4 v[108:111], v5, s[24:27], s20 offen
  s_add_u32 s20, s20, 0x10000
  buffer_load_dwordx4 v[112:115], v5, s[24:27], s20 offen
  s_add_u32 s20, s20, 0x10000
  buffer_load_dwordx4 v[116:119], v5, s[24:27], s20 offen
  s_add_u32 s20, s20, 0x10000
  buffer_load_dwordx4 v[120:123], v5, s[24:27], s20 offen
  s_add_u32 s20, s20, 0x10000
  buffer_load_dwordx4 v[124:127], v5, s[24:27], s20 offen
  s_add_u32 s20, s20, 0x10000
  buffer_load_dwordx4 v[128:131], v5, s[24:27], s20 offen
  s_add_u32 s20, s20, 0x10000
  buffer_load_dwordx4 v[132:135], v5, s[24:27], s20 offen
  s_add_u32 s20, s20, 0x10000
  buffer_load_dwordx4 v[136:139], v5, s[24:27], s20 offen
  s_add_u32 s20, s20, 0x10000
  buffer_load_dwordx4 v[140:143], v5, s[24:27], s20 offen
  s_add_u32 s20, s20, 0x10000
  buffer_load_dwordx4 v[144:147], v5, s[24:27], s20 offen
  s_add_u32 s20, s20, 0x10000
  buffer_load_dwordx4 v[148:151], v5, s[24:27], s20 offen
  s_add_u32 s20, s20, 0x10000
  buffer_load_dwordx4 v[152:155], v5, s[24:27], s20 offen
  s_add_u32 s20, s20, 0x10000
  buffer_load_dwordx4 v[156:159], v5, s[24:27], s20 offen
  s_add_u32 s20, s20, 0x10000
  buffer_load_dwordx4 v[160:163], v5, s[24:27], s20 offen
  s_add_u32 s20, s20, 0x10000
  buffer_load_dwordx4 v[164:167], v5, s[24:27], s20 offen
  s_add_u32 s20, s20, 0x10000
  buffer_load_dwordx4 v[168:171], v5, s[24:27], s20 offen
  s_add_u32 s20, s20, 0x10000
  buffer_load_dwordx4 v[172:175], v5, s[24:27], s20 offen
  s_add_u32 s20, s20, 0x10000
  v_lshlrev_b32 v4, 2, v4
  v_add_u32 v4, 8192, v4
  global_load_dword v32, v4, s[12:13]
  v_add_u32 v4, 0x100, v4
  global_load_dword v33, v4, s[12:13]
  v_add_u32 v4, 0x100, v4
  global_load_dword v34, v4, s[12:13]
  v_add_u32 v4, 0x100, v4
  global_load_dword v35, v4, s[12:13]
  v_add_u32 v4, 0x100, v4
  global_load_dword v36, v4, s[12:13]
  v_add_u32 v4, 0x100, v4
  global_load_dword v37, v4, s[12:13]
  v_add_u32 v4, 0x100, v4
  global_load_dword v38, v4, s[12:13]
  v_add_u32 v4, 0x100, v4
  global_load_dword v39, v4, s[12:13]
  v_add_u32 v4, 0x100, v4
  global_load_dword v40, v4, s[12:13]
  v_add_u32 v4, 0x100, v4
  global_load_dword v41, v4, s[12:13]
  v_add_u32 v4, 0x100, v4
  global_load_dword v42, v4, s[12:13]
  v_add_u32 v4, 0x100, v4
  global_load_dword v43, v4, s[12:13]
  v_add_u32 v4, 0x100, v4
  global_load_dword v44, v4, s[12:13]
  v_add_u32 v4, 0x100, v4
  global_load_dword v45, v4, s[12:13]
  v_add_u32 v4, 0x100, v4
  global_load_dword v46, v4, s[12:13]
  v_add_u32 v4, 0x100, v4
  global_load_dword v47, v4, s[12:13]
  v_add_u32 v4, 0x100, v4
  global_load_dword v48, v4, s[12:13]
  v_add_u32 v4, 0x100, v4
  global_load_dword v49, v4, s[12:13]
  v_add_u32 v4, 0x100, v4
  global_load_dword v50, v4, s[12:13]
  v_add_u32 v4, 0x100, v4
  global_load_dword v51, v4, s[12:13]
  v_add_u32 v4, 0x100, v4
  global_load_dword v52, v4, s[12:13]
  v_add_u32 v4, 0x100, v4
  global_load_dword v53, v4, s[12:13]
  v_add_u32 v4, 0x100, v4
  global_load_dword v54, v4, s[12:13]
  v_add_u32 v4, 0x100, v4
  global_load_dword v55, v4, s[12:13]
  v_add_u32 v4, 0x100, v4
  global_load_dword v56, v4, s[12:13]
  v_add_u32 v4, 0x100, v4
  global_load_dword v57, v4, s[12:13]
  v_add_u32 v4, 0x100, v4
  global_load_dword v58, v4, s[12:13]
  v_add_u32 v4, 0x100, v4
  global_load_dword v59, v4, s[12:13]
  v_add_u32 v4, 0x100, v4
  v_mov_b32 v8, 0
  v_mov_b32 v9, 0
  v_mov_b32 v10, 0
  v_mov_b32 v11, 0
  v_mov_b32 v12, 0
  v_mov_b32 v13, 0
  v_mov_b32 v14, 0
  v_mov_b32 v15, 0
  s_waitcnt vmcnt(0)
  FMA8 8, 64, v32
  FMA8 8, 68, v33
  FMA8 8, 72, v34
  FMA8 8, 76, v35
  FMA8 8, 80, v36
  FMA8 8, 84, v37
  FMA8 8, 88, v38
  FMA8 8, 92, v39
  FMA8 8, 96, v40
  FMA8 8, 100, v41
  FMA8 8, 104, v42
  FMA8 8, 108, v43
  FMA8 8, 112, v44
  FMA8 8, 116, v45
  FMA8 8, 120, v46
  FMA8 8, 124, v47
  FMA8 8, 128, v48
  FMA8 8, 132, v49
  FMA8 8, 136, v50
  FMA8 8, 140, v51
  FMA8 8, 144, v52
  FMA8 8, 148, v53
  FMA8 8, 152, v54
  FMA8 8, 156, v55
  FMA8 8, 160, v56
  FMA8 8, 164, v57
  FMA8 8, 168, v58
  FMA8 8, 172, v59

  s_barrier
  v_lshlrev_b32 v16, 5, v0
  ds_write_b128 v16, v[8:11]
  ds_write_b128 v16, v[12:15] offset:16
  s_waitcnt lgkmcnt(0)
  s_barrier
  v_and_b32 v16, 31, v0
  v_lshrrev_b32 v17, 5, v0
  v_lshlrev_b32 v17, 10, v17
  v_lshl_add_u32 v16, v16, 2, v17
  ds_read_b32 v8, v16
  ds_read_b32 v9, v16 offset:128
  ds_read_b32 v10, v16 offset:256
  ds_read_b32 v11, v16 offset:384
  ds_read_b32 v12, v16 offset:512
  ds_read_b32 v13, v16 offset:640
  ds_read_b32 v14, v16 offset:768
  ds_read_b32 v15, v16 offset:896
  s_waitcnt lgkmcnt(0)
  v_add_f32 v8, v8, v9
  v_add_f32 v10, v10, v11
  v_add_f32 v12, v12, v13
  v_add_f32 v14, v14, v15
  v_add_f32 v8, v8, v10
  v_add_f32 v12, v12, v14
  v_add_f32 v8, v8, v12
  v_lshlrev_b32 v16, 2, v0
  ds_write_b32 v16, v8 offset:8448
  s_waitcnt lgkmcnt(0)
  s_barrier
  v_and_b32 v16, 31, v0
  v_lshlrev_b32 v16, 2, v16
  ds_read_b32 v8, v16 offset:8448
  ds_read_b32 v9, v16 offset:8576
  ds_read_b32 v10, v16 offset:8704
  ds_read_b32 v11, v16 offset:8832
  ds_read_b32 v12, v16 offset:8960
  ds_read_b32 v13, v16 offset:9088
  ds_read_b32 v14, v16 offset:9216
  ds_read_b32 v15, v16 offset:9344
  s_waitcnt lgkmcnt(0)
  v_add_f32 v8, v8, v9
  v_add_f32 v10, v10, v11
  v_add_f32 v12, v12, v13
  v_add_f32 v14, v14, v15
  v_add_f32 v8, v8, v10
  v_add_f32 v12, v12, v14
  v_add_f32 v8, v8, v12

  v_cmp_gt_u32 vcc, 32, v0
  s_and_saveexec_b64 s[30:31], vcc
  s_cbranch_execz k3_end
  s_lshl_b32 s20, s18, 6
  v_lshl_add_u32 v9, v0, 1, s20
  global_load_ushort v10, v9, s[10:11]
  RBF v8
  s_waitcnt vmcnt(0)
  v_lshlrev_b32 v10, 16, v10
  v_add_f32 v8, v8, v10
  RBF v8
  v_mul_f32 v10, 0xbfb8aa3b, v8
  v_exp_f32 v10, v10
  s_nop 0
  v_add_f32 v10, 1.0, v10
  v_rcp_f32 v10, v10
  s_nop 0
  v_mul_f32 v8, v8, v10
  RBF v8
  v_lshlrev_b32 v9, 1, v9
  v_add_u32 v9, 1114112, v9
  global_store_dword v9, v8, s[12:13] sc1
  s_lshr_b32 s18, s18, 1
k3_arrive:
  s_waitcnt vmcnt(0)
  s_lshl_b32 s20, s18, 2
  v_mov_b32 v9, s20
  v_mov_b32 v10, 1
  s_mov_b64 s[32:33], exec
  s_mov_b64 exec, 1
  global_atomic_add v11, v9, v10, s[16:17] sc0
  s_waitcnt vmcnt(0)
  v_readfirstlane_b32 s21, v11
  s_mov_b64 exec, -1
  s_cmp_eq_u32 s21, 9
  s_cbranch_scc0 k3_end
  v_and_b32 v1, 63, v0
  s_lshl_b32 s20, s18, 8
  v_lshl_add_u32 v9, v1, 2, s20
  v_add_u32 v10, 1048576, v9
  v_add_u32 v11, 1114112, v9
  global_load_dword v20, v11, s[12:13] sc1

  global_load_dword v24, v10, s[12:13] sc1
  v_add_u32 v10, 0x800, v10
  global_load_dword v25, v10, s[12:13] sc1
  v_add_u32 v10, 0x800, v10
  global_load_dword v26, v10, s[12:13] sc1
  v_add_u32 v10, 0x800, v10
  global_load_dword v27, v10, s[12:13] sc1
  v_add_u32 v10, 0x800, v10
  global_load_dword v28, v10, s[12:13] sc1
  v_add_u32 v10, 0x800, v10
  global_load_dword v29, v10, s[12:13] sc1
  v_add_u32 v10, 0x800, v10
  global_load_dword v30, v10, s[12:13] sc1
  v_add_u32 v10, 0x800, v10
  global_load_dword v31, v10, s[12:13] sc1
  v_add_u32 v10, 0x800, v10

  v_lshrrev_b32 v9, 1, v9
  global_load_ushort v21, v9, s[4:5]
  s_waitcnt vmcnt(0)
  v_add_f32 v24, v24, v25
  v_add_f32 v26, v26, v27
  v_add_f32 v28, v28, v29
  v_add_f32 v30, v30, v31
  v_add_f32 v24, v24, v26
  v_add_f32 v28, v28, v30
  v_add_f32 v24, v24, v28
  RBF v24
  v_mul_f32 v24, v24, v20
  RBF v24
  v_lshlrev_b32 v21, 16, v21
  v_add_f32 v24, v24, v21
  v_cvt_pk_bf16_f32 v24, v24, v24
  global_store_short v9, v24, s[14:15]
k3_end:
  s_endpgm

.section .rodata,"a"
.p2align 6
.amdhsa_kernel k3_kernel
  .amdhsa_next_free_vgpr 192
  .amdhsa_next_free_sgpr 64
  .amdhsa_accum_offset 192
  .amdhsa_group_segment_fixed_size 0
  .amdhsa_kernarg_size 104
  .amdhsa_user_sgpr_count 2
  .amdhsa_user_sgpr_kernarg_segment_ptr 1
  .amdhsa_system_sgpr_workgroup_id_x 1
.end_amdhsa_kernel
.text
```
